```python
import torch

def _softmax(x, axis=-1):
    return torch.softmax(x, dim=axis)
def _gelu(x):
    return torch.nn.functional.gelu(x, approximate="tanh")
def _silu(x):
    return torch.nn.functional.silu(x)
def _sigmoid(x):
    return torch.sigmoid(x)
def _layernorm(x, axis=-1, eps=1e-5):
    m = x.mean(dim=axis, keepdim=True)
    v = x.var(dim=axis, keepdim=True, unbiased=False)
    return (x - m) / torch.sqrt(v + eps)
def _scatter_add(tgt, idx, src, axis=0):
    return tgt.clone().index_add_(axis, idx, src)
def _segment_sum(src, seg, n):
    out = torch.zeros((n,) + src.shape[1:], dtype=src.dtype)
    return out.index_add_(0, seg, src)
def _pad(x, pw):
    flat = tuple(v for pair in reversed(pw) for v in pair)
    return torch.nn.functional.pad(x, flat)

kernel_name = 'gated_mix__linear_attn_block__glu_gated_bilinear__prompt'

def setup_inputs():

    _w = (lambda a: (lambda t: t.to(torch.bfloat16) if t.is_floating_point() else t)(torch.as_tensor(a)))
    def _A_setup():
        B, S, D = 1, 2048, 512
        return {
            "x": _w((lambda *s: torch.randn(*s, dtype=torch.bfloat16) * 0.05)(B, S, D)),
            "wqkv": _w((lambda *s: torch.randn(*s, dtype=torch.bfloat16) * 0.8)(D, 3 * D)),
            "wo": _w((lambda *s: torch.randn(*s, dtype=torch.bfloat16) * 0.05)(D, D)),
        }
    _A_in = _A_setup()

    def _B_setup():
        B, S, D, F = 1, 2048, 512, 1792
        return {
            "x": _w((lambda *s: torch.randn(*s, dtype=torch.bfloat16) * 0.05)(B, S, D)),
            "w_gate": _w((lambda *s: torch.randn(*s, dtype=torch.bfloat16) * 1.6)(D, F) * (D ** -0.5)),
            "w_up": _w((lambda *s: torch.randn(*s, dtype=torch.bfloat16) * 1.6)(D, F) * (D ** -0.5)),
            "w_down": _w((lambda *s: torch.randn(*s, dtype=torch.bfloat16) * 1.6)(F, D) * (F ** -0.5)),
        }
    _B_in = _B_setup()

    return {
        "A_x": _A_in["x"],
        "A_wqkv": _A_in["wqkv"],
        "A_wo": _A_in["wo"],
        "B_x": _B_in["x"],
        "B_w_gate": _B_in["w_gate"],
        "B_w_up": _B_in["w_up"],
        "B_w_down": _B_in["w_down"],
        "gate_w": _w((lambda *s: torch.randn(*s, dtype=torch.bfloat16) * 0.05)(512) * 16.0),
    }

def reference(A_x, A_wqkv, A_wo, B_x, B_w_gate, B_w_up, B_w_down, gate_w):
    def _A_ref(x, wqkv, wo):
        B, S, D = x.shape
        H = 32; Dh = D // H
        qkv = (lambda x, *d: x.permute(*d))((x @ wqkv).reshape(B, S, 3, H, Dh), 2, 0, 3, 1, 4)
        q, k, v = qkv[0], qkv[1], qkv[2]
        phi = lambda t: torch.where(t > 0, t + 1, torch.exp(t)) + 1e-6
        pq, pk = phi(q), phi(k)
        kv = torch.einsum("bhsd,bhse->bhde", pk, v)
        z = torch.einsum("bhsd->bhd", pk)
        num = torch.einsum("bhqd,bhde->bhqe", pq, kv)
        den = torch.einsum("bhqd,bhd->bhq", pq, z)[..., None] + 1e-6
        o = num / den
        return (lambda x, *d: x.permute(*d))(o, 0, 2, 1, 3).reshape(B, S, D) @ wo

    def _B_ref(x, w_gate, w_up, w_down):
        g = torch.einsum("bsd,df->bsf", x, w_gate)
        u = torch.einsum("bsd,df->bsf", x, w_up)
        h = g * u
        return torch.einsum("bsf,fd->bsd", h, w_down)

    x = A_x
    g = _sigmoid((x * gate_w).sum(-1, keepdims=True))
    a = _A_ref(x, A_wqkv, A_wo)
    b = _B_ref(x, B_w_gate, B_w_up, B_w_down)
    return g * a + (1 - g) * b
```

```asm
; @launch grid=(256,1,1) block=(512,1,1) lds=163840
.amdgcn_target "amdgcn-amd-amdhsa--gfx950"
.text
.globl gated_mix__linear_attn_block__glu_gated_bilinear__prompt_kernel
.p2align 8
.type gated_mix__linear_attn_block__glu_gated_bilinear__prompt_kernel,@function
gated_mix__linear_attn_block__glu_gated_bilinear__prompt_kernel:
    s_cmp_ge_u32 s2, 256
    s_cbranch_scc1 L_END
    s_getpc_b64 s[82:83]
    s_load_dwordx4 s[4:7], s[0:1], 0
    s_load_dwordx8 s[8:15], s[0:1], 32
    s_load_dwordx4 s[16:19], s[0:1], 72
    s_load_dwordx2 s[84:85], s[0:1], 64
    s_load_dwordx2 s[86:87], s[0:1], 16
    v_lshrrev_b32 v1, 6, v0
    v_and_b32 v0, 63, v0
    s_and_b32 s20, s2, 7
    v_readfirstlane_b32 s23, v1
    s_lshr_b32 s21, s2, 3
    s_and_b32 s53, s21, 3
    s_lshr_b32 s78, s21, 2
    s_and_b32 s52, s20, 1
    s_lshr_b32 s54, s20, 1
    s_lshl2_add_u32 s77, s52, s54
    s_lshl2_add_u32 s77, s77, s53
    s_lshl2_add_u32 s20, s52, s53
    s_lshl3_add_u32 s3, s54, s78
    s_sub_u32 s21, s3, s54
    s_sub_u32 s21, s21, 1
    s_add_u32 s54, s54, 28
    s_cmp_eq_u32 s78, 0
    s_cselect_b32 s21, s54, s21
    s_and_b32 s52, s54, 2
    s_xor_b32 s78, s78, s52
    s_and_b32 s22, s23, 3
    s_mov_b32 s56, 0x1c0000
    s_mov_b32 s57, 0x180000
    s_cmp_lt_u32 s21, 28
    s_cselect_b32 s30, s56, s57
    s_cselect_b32 s34, s56, s57
    s_movk_i32 s56, 3584
    s_movk_i32 s55, 3072
    s_cselect_b32 s58, s56, s55
    s_mov_b32 s38, s57
    s_mov_b32 s26, 0x200000
    s_mov_b32 s31, 0x20000
    s_mov_b32 s35, 0x20000
    s_mov_b32 s39, 0x20000
    s_mov_b32 s27, 0x20000
    s_xor_b32 s23, s23, 4
    s_cmp_ge_u32 s23, 4
    s_cbranch_scc1 L_COMPUTE
    v_lshrrev_b32 v7, 3, v0
    v_and_b32 v8, 7, v0
    v_lshrrev_b32 v4, 4, v0
    v_and_b32 v6, 1, v4
    v_lshlrev_b32 v6, 2, v6
    v_xor_b32 v6, v8, v6
    v_lshlrev_b32 v6, 4, v6
    v_mad_u32_u24 v1, v7, s58, v6
    s_lshl_b32 s64, s58, 3
    s_sub_u32 s64, s64, 1024
    v_xor_b32 v6, 16, v6
    v_add_u32 v6, s64, v6
    v_mad_u32_u24 v2, v7, s58, v6
    v_xor_b32 v5, v8, v4
    v_lshlrev_b32 v5, 4, v5
    v_lshl_add_u32 v10, v7, 10, v5
    v_xor_b32 v5, 64, v10
    v_add_u32 v11, 7168, v5
    v_add_u32 v12, 14336, v10
    v_add_u32 v13, 21504, v5
    v_lshrrev_b32 v7, 2, v0
    v_bfe_u32 v8, v0, 1, 1
    v_lshrrev_b32 v4, 5, v0
    v_xor_b32 v8, v8, v4
    v_and_b32 v4, 1, v0
    v_lshlrev_b32 v4, 4, v4
    v_lshl_add_u32 v4, v8, 10, v4
    v_mad_u32_u24 v3, v7, s55, v4
    s_lshl_b32 s60, s20, 18
    s_lshl_b32 s52, s22, 16
    s_add_u32 s60, s60, s52
    s_lshl_b32 s52, s21, 7
    s_sub_u32 s53, s21, 28
    s_lshl_b32 s53, s53, 8
    s_add_u32 s54, s53, 128
    s_cmp_lt_u32 s21, 28
    s_cselect_b32 s61, s52, s53
    s_cselect_b32 s62, s52, s54
    s_lshl_b32 s52, s22, 4
    s_mul_i32 s53, s52, s58
    s_add_u32 s61, s61, s53
    s_add_u32 s62, s62, s53
    s_mul_i32 s63, s52, s55
    s_lshl_b32 s53, s3, 5
    s_add_u32 s63, s63, s53
    s_add_u32 s63, s63, 1024
    s_lshl_b32 s65, s58, 6
    s_mul_i32 s66, s22, 24576
    s_lshl_b32 s67, s22, 11
    s_add_u32 s67, s67, 0x18000
    s_lshl_b32 s68, s22, 10
    s_add_u32 s68, s68, 0x1c000
    s_add_u32 s72, s20, s3
    s_add_u32 s76, s72, 0
    s_and_b32 s76, s76, 1
    s_mul_i32 s74, s76, s65
    s_add_u32 s82, s74, s62
    s_add_u32 s74, s74, s61
    s_lshl_b32 s73, s76, 7
    s_add_u32 s73, s73, s60
    s_add_u32 s64, s73, 0x8000
    s_mul_i32 s75, s76, 196608
    s_add_u32 s75, s75, s63
    s_waitcnt lgkmcnt(0)
    s_cmp_lt_u32 s21, 28
    s_cselect_b32 s28, s8, s6
    s_cselect_b32 s29, s9, s7
    s_cselect_b32 s32, s10, s6
    s_cselect_b32 s33, s11, s7
    s_and_b32 s29, s29, 0xffff
    s_and_b32 s33, s33, 0xffff
    s_mov_b32 s36, s6
    s_and_b32 s37, s7, 0xffff
    s_mov_b32 s24, s4
    s_and_b32 s25, s5, 0xffff
    s_add_u32 m0, s67, 0
    s_nop 0
    buffer_load_dwordx4 v1, s[28:31], s74 offen lds
    buffer_load_dwordx4 v2, s[28:31], s74 offen offset:1024 lds
    s_add_u32 m0, s67, 8192
    s_nop 0
    buffer_load_dwordx4 v1, s[32:35], s82 offen lds
    buffer_load_dwordx4 v2, s[32:35], s82 offen offset:1024 lds
    s_add_u32 m0, s68, 0
    s_nop 0
    buffer_load_dwordx4 v3, s[36:39], s75 offen lds
    s_add_u32 m0, s66, 0
    s_nop 0
    buffer_load_dwordx4 v10, s[24:27], s73 offen lds
    buffer_load_dwordx4 v11, s[24:27], s73 offen offset:1024 lds
    buffer_load_dwordx4 v12, s[24:27], s73 offen offset:2048 lds
    buffer_load_dwordx4 v13, s[24:27], s73 offen offset:3072 lds
    s_add_u32 m0, s66, 4096
    s_nop 0
    buffer_load_dwordx4 v10, s[24:27], s64 offen lds
    buffer_load_dwordx4 v11, s[24:27], s64 offen offset:1024 lds
    buffer_load_dwordx4 v12, s[24:27], s64 offen offset:2048 lds
    buffer_load_dwordx4 v13, s[24:27], s64 offen offset:3072 lds
    s_add_u32 s76, s72, 1
    s_and_b32 s76, s76, 1
    s_mul_i32 s74, s76, s65
    s_add_u32 s82, s74, s62
    s_add_u32 s74, s74, s61
    s_lshl_b32 s73, s76, 7
    s_add_u32 s73, s73, s60
    s_add_u32 s64, s73, 0x8000
    s_mul_i32 s75, s76, 196608
    s_add_u32 s75, s75, s63
    s_add_u32 m0, s67, 20480
    s_nop 0
    buffer_load_dwordx4 v1, s[28:31], s74 offen lds
    buffer_load_dwordx4 v2, s[28:31], s74 offen offset:1024 lds
    s_add_u32 m0, s67, 28672
    s_nop 0
    buffer_load_dwordx4 v1, s[32:35], s82 offen lds
    buffer_load_dwordx4 v2, s[32:35], s82 offen offset:1024 lds
    s_add_u32 m0, s68, 20480
    s_nop 0
    buffer_load_dwordx4 v3, s[36:39], s75 offen lds
    s_add_u32 m0, s66, 8192
    s_nop 0
    buffer_load_dwordx4 v10, s[24:27], s73 offen lds
    buffer_load_dwordx4 v11, s[24:27], s73 offen offset:1024 lds
    buffer_load_dwordx4 v12, s[24:27], s73 offen offset:2048 lds
    buffer_load_dwordx4 v13, s[24:27], s73 offen offset:3072 lds
    s_mov_b32 s40, s18
    s_and_b32 s41, s19, 0xffff
    s_mov_b32 s42, 0x2000000
    s_mov_b32 s43, 0x20000
    s_mov_b32 s44, s16
    s_and_b32 s45, s17, 0xffff
    s_mov_b32 s46, 0x100
    s_mov_b32 s47, 0x20000
    s_mov_b32 s48, s14
    s_and_b32 s49, s15, 0xffff
    s_mov_b32 s50, 0x400
    s_mov_b32 s51, 0x20000
    s_mov_b32 s88, s12
    s_and_b32 s89, s13, 0xffff
    s_mov_b32 s90, 0x1c0000
    s_mov_b32 s91, 0x20000
    s_mov_b32 s92, s84
    s_and_b32 s93, s85, 0xffff
    s_mov_b32 s94, 0x200000
    s_mov_b32 s95, 0x20000
    s_mov_b32 s96, s86
    s_and_b32 s97, s87, 0xffff
    s_mov_b32 s98, 0x80000
    s_mov_b32 s99, 0x20000
    v_lshlrev_b32 v14, 4, v0
    v_lshrrev_b32 v4, 3, v0
    v_and_b32 v5, 7, v0
    v_lshlrev_b32 v5, 4, v5
    v_lshl_add_u32 v5, v4, 11, v5
    s_lshl_b32 s52, s78, 7
    v_add_u32 v6, s52, v5
    v_xor_b32 v7, 64, v6
    v_bfe_u32 v8, v0, 1, 1
    v_bfe_u32 v4, v0, 4, 1
    v_lshl_add_u32 v8, v4, 1, v8
    v_bfe_u32 v4, v0, 2, 1
    v_lshl_add_u32 v8, v4, 2, v8
    v_lshlrev_b32 v8, 4, v8
    v_lshl_add_u32 v8, v4, 10, v8
    v_and_b32 v4, 1, v0
    v_lshl_add_u32 v8, v4, 3, v8
    v_bfe_u32 v4, v0, 3, 1
    v_lshl_add_u32 v8, v4, 7, v8
    v_lshrrev_b32 v4, 5, v0
    v_lshl_add_u32 v8, v4, 8, v8
    v_add_u32 v8, s66, v8
    v_xor_b32 v9, 64, v8
    s_and_b32 s54, s77, 3
    s_mul_i32 s56, s54, 7
    s_mul_i32 s57, s78, 7
    s_lshr_b32 s57, s57, 1
    s_add_u32 s56, s56, s57
    s_sub_u32 s57, s56, 28
    s_cmp_ge_u32 s56, 28
    s_cselect_b32 s56, s57, s56
    s_lshl_b32 s79, s56, 10
    s_mov_b32 s80, s79
    s_mul_i32 s81, s22, 458752
    s_movk_i32 s59, 28672
    s_waitcnt vmcnt(9)
    s_barrier
    s_add_u32 m0, s66, 12288
    s_nop 0
    buffer_load_dwordx4 v10, s[24:27], s64 offen lds
    buffer_load_dwordx4 v11, s[24:27], s64 offen offset:1024 lds
    buffer_load_dwordx4 v12, s[24:27], s64 offen offset:2048 lds
    buffer_load_dwordx4 v13, s[24:27], s64 offen offset:3072 lds
    s_add_u32 s76, s72, 0
    s_mul_i32 s74, s76, 86
    s_lshr_b32 s74, s74, 8
    s_mul_i32 s74, s74, 3
    s_sub_u32 s76, s76, s74
    s_add_u32 s76, s76, 2
    s_mul_i32 s74, s76, s65
    s_add_u32 s82, s74, s62
    s_add_u32 s74, s74, s61
    s_lshl_b32 s73, s76, 7
    s_add_u32 s73, s73, s60
    s_add_u32 s64, s73, 0x8000
    s_mul_i32 s75, s76, 196608
    s_add_u32 s75, s75, s63
    s_add_u32 m0, s67, 40960
    s_nop 0
    buffer_load_dwordx4 v1, s[28:31], s74 offen lds
    buffer_load_dwordx4 v2, s[28:31], s74 offen offset:1024 lds
    s_add_u32 m0, s67, 49152
    s_nop 0
    buffer_load_dwordx4 v1, s[32:35], s82 offen lds
    buffer_load_dwordx4 v2, s[32:35], s82 offen offset:1024 lds
    s_add_u32 m0, s68, 40960
    s_nop 0
    buffer_load_dwordx4 v3, s[36:39], s75 offen lds
    s_add_u32 m0, s66, 16384
    s_nop 0
    buffer_load_dwordx4 v10, s[24:27], s73 offen lds
    buffer_load_dwordx4 v11, s[24:27], s73 offen offset:1024 lds
    buffer_load_dwordx4 v12, s[24:27], s73 offen offset:2048 lds
    buffer_load_dwordx4 v13, s[24:27], s73 offen offset:3072 lds
    s_add_u32 m0, s66, 20480
    s_nop 0
    buffer_load_dwordx4 v10, s[24:27], s64 offen lds
    buffer_load_dwordx4 v11, s[24:27], s64 offen offset:1024 lds
    buffer_load_dwordx4 v12, s[24:27], s64 offen offset:2048 lds
    buffer_load_dwordx4 v13, s[24:27], s64 offen offset:3072 lds
    s_waitcnt vmcnt(13)
    s_barrier
    s_add_u32 s76, s72, 1
    s_mul_i32 s74, s76, 86
    s_lshr_b32 s74, s74, 8
    s_mul_i32 s74, s74, 3
    s_sub_u32 s76, s76, s74
    s_add_u32 s76, s76, 2
    s_mul_i32 s74, s76, s65
    s_add_u32 s82, s74, s62
    s_add_u32 s74, s74, s61
    s_lshl_b32 s73, s76, 7
    s_add_u32 s73, s73, s60
    s_add_u32 s64, s73, 0x8000
    s_mul_i32 s75, s76, 196608
    s_add_u32 s75, s75, s63
    s_add_u32 m0, s67, 0
    s_nop 0
    buffer_load_dwordx4 v1, s[28:31], s74 offen lds
    buffer_load_dwordx4 v2, s[28:31], s74 offen offset:1024 lds
    s_add_u32 m0, s67, 8192
    s_nop 0
    buffer_load_dwordx4 v1, s[32:35], s82 offen lds
    buffer_load_dwordx4 v2, s[32:35], s82 offen offset:1024 lds
    s_add_u32 m0, s68, 0
    s_nop 0
    buffer_load_dwordx4 v3, s[36:39], s75 offen lds
    s_add_u32 m0, s66, 0
    s_nop 0
    buffer_load_dwordx4 v10, s[24:27], s73 offen lds
    buffer_load_dwordx4 v11, s[24:27], s73 offen offset:1024 lds
    buffer_load_dwordx4 v12, s[24:27], s73 offen offset:2048 lds
    buffer_load_dwordx4 v13, s[24:27], s73 offen offset:3072 lds
    s_add_u32 m0, s66, 4096
    s_nop 0
    buffer_load_dwordx4 v10, s[24:27], s64 offen lds
    buffer_load_dwordx4 v11, s[24:27], s64 offen offset:1024 lds
    buffer_load_dwordx4 v12, s[24:27], s64 offen offset:2048 lds
    buffer_load_dwordx4 v13, s[24:27], s64 offen offset:3072 lds
    s_waitcnt vmcnt(13)
    s_barrier
    s_add_u32 s76, s72, 2
    s_mul_i32 s74, s76, 86
    s_lshr_b32 s74, s74, 8
    s_mul_i32 s74, s74, 3
    s_sub_u32 s76, s76, s74
    s_add_u32 s76, s76, 2
    s_mul_i32 s74, s76, s65
    s_add_u32 s82, s74, s62
    s_add_u32 s74, s74, s61
    s_lshl_b32 s73, s76, 7
    s_add_u32 s73, s73, s60
    s_add_u32 s64, s73, 0x8000
    s_mul_i32 s75, s76, 196608
    s_add_u32 s75, s75, s63
    s_add_u32 m0, s67, 20480
    s_nop 0
    buffer_load_dwordx4 v1, s[28:31], s74 offen lds
    buffer_load_dwordx4 v2, s[28:31], s74 offen offset:1024 lds
    s_add_u32 m0, s67, 28672
    s_nop 0
    buffer_load_dwordx4 v1, s[32:35], s82 offen lds
    buffer_load_dwordx4 v2, s[32:35], s82 offen offset:1024 lds
    s_add_u32 m0, s68, 20480
    s_nop 0
    buffer_load_dwordx4 v3, s[36:39], s75 offen lds
    s_add_u32 m0, s66, 8192
    s_nop 0
    buffer_load_dwordx4 v10, s[24:27], s73 offen lds
    buffer_load_dwordx4 v11, s[24:27], s73 offen offset:1024 lds
    buffer_load_dwordx4 v12, s[24:27], s73 offen offset:2048 lds
    buffer_load_dwordx4 v13, s[24:27], s73 offen offset:3072 lds
    s_add_u32 m0, s66, 12288
    s_nop 0
    buffer_load_dwordx4 v10, s[24:27], s64 offen lds
    buffer_load_dwordx4 v11, s[24:27], s64 offen offset:1024 lds
    buffer_load_dwordx4 v12, s[24:27], s64 offen offset:2048 lds
    buffer_load_dwordx4 v13, s[24:27], s64 offen offset:3072 lds
    s_waitcnt vmcnt(13)
    s_barrier
    s_add_u32 s76, s72, 0
    s_mul_i32 s74, s76, 86
    s_lshr_b32 s74, s74, 8
    s_mul_i32 s74, s74, 3
    s_sub_u32 s76, s76, s74
    s_add_u32 s76, s76, 5
    s_mul_i32 s74, s76, s65
    s_add_u32 s82, s74, s62
    s_add_u32 s74, s74, s61
    s_lshl_b32 s73, s76, 7
    s_add_u32 s73, s73, s60
    s_add_u32 s64, s73, 0x8000
    s_mul_i32 s75, s76, 196608
    s_add_u32 s75, s75, s63
    s_add_u32 m0, s67, 40960
    s_nop 0
    buffer_load_dwordx4 v1, s[28:31], s74 offen lds
    buffer_load_dwordx4 v2, s[28:31], s74 offen offset:1024 lds
    s_add_u32 m0, s67, 49152
    s_nop 0
    buffer_load_dwordx4 v1, s[32:35], s82 offen lds
    buffer_load_dwordx4 v2, s[32:35], s82 offen offset:1024 lds
    s_add_u32 m0, s68, 40960
    s_nop 0
    buffer_load_dwordx4 v3, s[36:39], s75 offen lds
    s_add_u32 m0, s66, 16384
    s_nop 0
    buffer_load_dwordx4 v10, s[24:27], s73 offen lds
    buffer_load_dwordx4 v11, s[24:27], s73 offen offset:1024 lds
    buffer_load_dwordx4 v12, s[24:27], s73 offen offset:2048 lds
    buffer_load_dwordx4 v13, s[24:27], s73 offen offset:3072 lds
    s_add_u32 m0, s66, 20480
    s_nop 0
    buffer_load_dwordx4 v10, s[24:27], s64 offen lds
    buffer_load_dwordx4 v11, s[24:27], s64 offen offset:1024 lds
    buffer_load_dwordx4 v12, s[24:27], s64 offen offset:2048 lds
    buffer_load_dwordx4 v13, s[24:27], s64 offen offset:3072 lds
    s_and_b32 s52, s2, 7
    s_xor_b32 s52, s52, 4
    s_lshr_b32 s53, s2, 3
    s_sub_u32 s56, s53, 16
    s_mul_i32 s56, s56, 6
    s_add_u32 s56, s56, s52
    s_lshl2_add_u32 s56, s56, s22
    s_mul_i32 s54, s56, 4864
    s_cmp_lt_u32 s52, 6
    s_cselect_b32 s54, s54, 0x40000000
    s_cmp_ge_u32 s53, 16
    s_cselect_b32 s54, s54, 0x40000000
    v_min_u32 v4, 37, v0
    v_lshlrev_b32 v4, 7, v4
    v_add_u32 v4, s54, v4
    buffer_load_dword v146, v4, s[88:91], 0 offen
    s_and_b32 s52, s2, 7
    s_xor_b32 s52, s52, 4
    s_lshr_b32 s53, s2, 3
    s_sub_u32 s56, s53, 16
    s_mul_i32 s56, s56, 6
    s_add_u32 s56, s56, s52
    s_lshl2_add_u32 s56, s56, s22
    s_mul_i32 s54, s56, 1408
    s_cmp_lt_u32 s52, 6
    s_cselect_b32 s54, s54, 0x40000000
    s_cmp_ge_u32 s53, 16
    s_cselect_b32 s54, s54, 0x40000000
    v_min_u32 v4, 10, v0
    v_lshlrev_b32 v4, 7, v4
    v_add_u32 v4, s54, v4
    buffer_load_dword v146, v4, s[96:99], 0 offen
    s_waitcnt vmcnt(15)
    s_barrier
    s_add_u32 s76, s72, 1
    s_mul_i32 s74, s76, 86
    s_lshr_b32 s74, s74, 8
    s_mul_i32 s74, s74, 3
    s_sub_u32 s76, s76, s74
    s_add_u32 s76, s76, 5
    s_mul_i32 s74, s76, s65
    s_add_u32 s82, s74, s62
    s_add_u32 s74, s74, s61
    s_lshl_b32 s73, s76, 7
    s_add_u32 s73, s73, s60
    s_add_u32 s64, s73, 0x8000
    s_mul_i32 s75, s76, 196608
    s_add_u32 s75, s75, s63
    s_add_u32 m0, s67, 0
    s_nop 0
    buffer_load_dwordx4 v1, s[28:31], s74 offen lds
    buffer_load_dwordx4 v2, s[28:31], s74 offen offset:1024 lds
    s_add_u32 m0, s67, 8192
    s_nop 0
    buffer_load_dwordx4 v1, s[32:35], s82 offen lds
    buffer_load_dwordx4 v2, s[32:35], s82 offen offset:1024 lds
    s_add_u32 m0, s68, 0
    s_nop 0
    buffer_load_dwordx4 v3, s[36:39], s75 offen lds
    s_add_u32 m0, s66, 0
    s_nop 0
    buffer_load_dwordx4 v10, s[24:27], s73 offen lds
    buffer_load_dwordx4 v11, s[24:27], s73 offen offset:1024 lds
    buffer_load_dwordx4 v12, s[24:27], s73 offen offset:2048 lds
    buffer_load_dwordx4 v13, s[24:27], s73 offen offset:3072 lds
    s_add_u32 m0, s66, 4096
    s_nop 0
    buffer_load_dwordx4 v10, s[24:27], s64 offen lds
    buffer_load_dwordx4 v11, s[24:27], s64 offen offset:1024 lds
    buffer_load_dwordx4 v12, s[24:27], s64 offen offset:2048 lds
    buffer_load_dwordx4 v13, s[24:27], s64 offen offset:3072 lds
    s_waitcnt vmcnt(15)
    s_barrier
    s_add_u32 s76, s72, 2
    s_mul_i32 s74, s76, 86
    s_lshr_b32 s74, s74, 8
    s_mul_i32 s74, s74, 3
    s_sub_u32 s76, s76, s74
    s_add_u32 s76, s76, 5
    s_mul_i32 s74, s76, s65
    s_add_u32 s82, s74, s62
    s_add_u32 s74, s74, s61
    s_lshl_b32 s73, s76, 7
    s_add_u32 s73, s73, s60
    s_add_u32 s64, s73, 0x8000
    s_mul_i32 s75, s76, 196608
    s_add_u32 s75, s75, s63
    s_add_u32 m0, s67, 20480
    s_nop 0
    buffer_load_dwordx4 v1, s[28:31], s74 offen lds
    buffer_load_dwordx4 v2, s[28:31], s74 offen offset:1024 lds
    s_add_u32 m0, s67, 28672
    s_nop 0
    buffer_load_dwordx4 v1, s[32:35], s82 offen lds
    buffer_load_dwordx4 v2, s[32:35], s82 offen offset:1024 lds
    s_add_u32 m0, s68, 20480
    s_nop 0
    buffer_load_dwordx4 v3, s[36:39], s75 offen lds
    s_add_u32 m0, s66, 8192
    s_nop 0
    buffer_load_dwordx4 v10, s[24:27], s73 offen lds
    buffer_load_dwordx4 v11, s[24:27], s73 offen offset:1024 lds
    buffer_load_dwordx4 v12, s[24:27], s73 offen offset:2048 lds
    buffer_load_dwordx4 v13, s[24:27], s73 offen offset:3072 lds
    s_add_u32 m0, s66, 12288
    s_nop 0
    buffer_load_dwordx4 v10, s[24:27], s64 offen lds
    buffer_load_dwordx4 v11, s[24:27], s64 offen offset:1024 lds
    buffer_load_dwordx4 v12, s[24:27], s64 offen offset:2048 lds
    buffer_load_dwordx4 v13, s[24:27], s64 offen offset:3072 lds
    v_and_b32 v145, 31, v0
    v_lshlrev_b32 v145, 2, v145
    buffer_load_dword v144, v145, s[44:47], 0 offen sc0 sc1
    v_add_u32 v13, s66, v14
    v_and_b32 v3, 31, v0
    v_lshlrev_b32 v3, 6, v3
    s_lshl_b32 s83, s77, 11
    s_add_u32 s83, s83, 0xb90000
    s_waitcnt vmcnt(14)
    s_barrier
    s_add_u32 s79, s80, 0
    s_sub_u32 s52, s79, s59
    s_cselect_b32 s79, s79, s52
    s_add_u32 m0, s66, 16384
    s_lshl4_add_u32 s52, s79, s81
    buffer_load_dwordx4 v6, s[88:91], s52 offen lds
    buffer_load_dwordx4 v7, s[88:91], s52 offen offset:1024 lds
    s_addk_i32 s79, 1024
    s_cmp_eq_u32 s79, s59
    s_cselect_b32 s79, 0, s79
    s_add_u32 m0, s66, 18432
    s_lshl4_add_u32 s52, s79, s81
    buffer_load_dwordx4 v6, s[88:91], s52 offen lds
    buffer_load_dwordx4 v7, s[88:91], s52 offen offset:1024 lds
    s_addk_i32 s79, 1024
    s_cmp_eq_u32 s79, s59
    s_cselect_b32 s79, 0, s79
    s_add_u32 m0, s66, 20480
    s_lshl4_add_u32 s52, s79, s81
    buffer_load_dwordx4 v6, s[88:91], s52 offen lds
    buffer_load_dwordx4 v7, s[88:91], s52 offen offset:1024 lds
    s_addk_i32 s79, 1024
    s_cmp_eq_u32 s79, s59
    s_cselect_b32 s79, 0, s79
    s_add_u32 m0, s66, 22528
    s_lshl4_add_u32 s52, s79, s81
    buffer_load_dwordx4 v6, s[88:91], s52 offen lds
    buffer_load_dwordx4 v7, s[88:91], s52 offen offset:1024 lds
    s_lshl_b32 s52, s22, 8
    s_add_u32 s53, s52, 0x22000
    v_lshlrev_b32 v12, 2, v0
    v_add_u32 v4, s53, v12
    s_lshl_b32 s70, s3, 11
    s_add_u32 s70, s70, 0xb00000
    s_lshl_b32 s69, s22, 9
    s_add_u32 s69, s69, s70
    s_lshl2_add_u32 s71, s20, s22
    s_lshl2_add_u32 s71, s71, s70
    v_mov_b32 v5, 1
    s_mul_i32 s52, s77, 229376
    s_mul_i32 s53, s22, 28672
    s_add_u32 s52, s52, s53
    v_add_u32 v1, s52, v14
    v_add_u32 v2, 114688, v1
    s_mul_i32 s52, s22, 7
    s_lshl_b32 s60, 0x7f, s52
    s_and_b32 s53, s77, 3
    s_lshl3_add_u32 s53, s53, s23
    s_lshl_b32 s53, 1, s53
    s_or_b32 s60, s60, s53
    s_waitcnt vmcnt(9)
    s_barrier
    s_waitcnt vmcnt(8)
    s_movk_i32 s57, 0x7fff
L_DPOLL:
    v_cmp_ne_u32 vcc, 0, v144
    s_cmp_eq_u32 vcc_lo, -1
    s_cbranch_scc1 L_DPOLL_OK
    s_sleep 1
    buffer_load_dword v144, v145, s[44:47], 0 offen sc0 sc1
    s_waitcnt vmcnt(0)
    s_sub_u32 s57, s57, 1
    s_cmp_lg_u32 s57, 0
    s_cbranch_scc1 L_DPOLL
L_DPOLL_OK:
    s_add_u32 s79, s80, 4096
    s_sub_u32 s52, s79, s59
    s_cselect_b32 s79, s79, s52
    s_add_u32 m0, s66, 0
    s_lshl4_add_u32 s52, s79, s81
    buffer_load_dwordx4 v6, s[88:91], s52 offen lds
    buffer_load_dwordx4 v7, s[88:91], s52 offen offset:1024 lds
    s_addk_i32 s79, 1024
    s_cmp_eq_u32 s79, s59
    s_cselect_b32 s79, 0, s79
    s_add_u32 m0, s66, 2048
    s_lshl4_add_u32 s52, s79, s81
    buffer_load_dwordx4 v6, s[88:91], s52 offen lds
    buffer_load_dwordx4 v7, s[88:91], s52 offen offset:1024 lds
    s_addk_i32 s79, 1024
    s_cmp_eq_u32 s79, s59
    s_cselect_b32 s79, 0, s79
    s_add_u32 m0, s66, 4096
    s_lshl4_add_u32 s52, s79, s81
    buffer_load_dwordx4 v6, s[88:91], s52 offen lds
    buffer_load_dwordx4 v7, s[88:91], s52 offen offset:1024 lds
    s_addk_i32 s79, 1024
    s_cmp_eq_u32 s79, s59
    s_cselect_b32 s79, 0, s79
    s_add_u32 m0, s66, 6144
    s_lshl4_add_u32 s52, s79, s81
    buffer_load_dwordx4 v6, s[88:91], s52 offen lds
    buffer_load_dwordx4 v7, s[88:91], s52 offen offset:1024 lds
    s_waitcnt vmcnt(14)
    ds_read_b64_tr_b16 v[16:17], v8 offset:16384
    ds_read_b64_tr_b16 v[18:19], v8 offset:16896
    ds_read_b64_tr_b16 v[20:21], v9 offset:16384
    ds_read_b64_tr_b16 v[22:23], v9 offset:16896
    s_waitcnt vmcnt(12)
    ds_read_b64_tr_b16 v[24:25], v8 offset:18432
    ds_read_b64_tr_b16 v[26:27], v8 offset:18944
    ds_read_b64_tr_b16 v[28:29], v9 offset:18432
    ds_read_b64_tr_b16 v[30:31], v9 offset:18944
    s_waitcnt vmcnt(10)
    ds_read_b64_tr_b16 v[32:33], v8 offset:20480
    ds_read_b64_tr_b16 v[34:35], v8 offset:20992
    ds_read_b64_tr_b16 v[36:37], v9 offset:20480
    ds_read_b64_tr_b16 v[38:39], v9 offset:20992
    s_waitcnt vmcnt(8)
    ds_read_b64_tr_b16 v[40:41], v8 offset:22528
    ds_read_b64_tr_b16 v[42:43], v8 offset:23040
    ds_read_b64_tr_b16 v[44:45], v9 offset:22528
    s_waitcnt lgkmcnt(14)
    ds_read_b64_tr_b16 v[46:47], v9 offset:23040
    s_add_u32 s79, s80, 8192
    s_sub_u32 s52, s79, s59
    s_cselect_b32 s79, s79, s52
    s_waitcnt lgkmcnt(0)
    s_add_u32 m0, s66, 16384
    s_lshl4_add_u32 s52, s79, s81
    buffer_load_dwordx4 v6, s[88:91], s52 offen lds
    buffer_load_dwordx4 v7, s[88:91], s52 offen offset:1024 lds
    s_addk_i32 s79, 1024
    s_cmp_eq_u32 s79, s59
    s_cselect_b32 s79, 0, s79
    s_add_u32 m0, s66, 18432
    s_lshl4_add_u32 s52, s79, s81
    buffer_load_dwordx4 v6, s[88:91], s52 offen lds
    buffer_load_dwordx4 v7, s[88:91], s52 offen offset:1024 lds
    s_addk_i32 s79, 1024
    s_cmp_eq_u32 s79, s59
    s_cselect_b32 s79, 0, s79
    s_add_u32 m0, s66, 20480
    s_lshl4_add_u32 s52, s79, s81
    buffer_load_dwordx4 v6, s[88:91], s52 offen lds
    buffer_load_dwordx4 v7, s[88:91], s52 offen offset:1024 lds
    s_addk_i32 s79, 1024
    s_cmp_eq_u32 s79, s59
    s_cselect_b32 s79, 0, s79
    s_add_u32 m0, s66, 22528
    s_lshl4_add_u32 s52, s79, s81
    buffer_load_dwordx4 v6, s[88:91], s52 offen lds
    buffer_load_dwordx4 v7, s[88:91], s52 offen offset:1024 lds
    s_add_u32 s79, s80, 24576
    s_sub_u32 s52, s79, s59
    s_cselect_b32 s79, s79, s52
    s_lshl4_add_u32 s52, s79, s81
    buffer_load_dwordx4 v[248:251], v6, s[88:91], s52 offen
    buffer_load_dwordx4 v[252:255], v7, s[88:91], s52 offen offset:1024
    s_addk_i32 s79, 1024
    s_cmp_eq_u32 s79, s59
    s_cselect_b32 s79, 0, s79
    s_lshl4_add_u32 s52, s79, s81
    buffer_load_dwordx4 v[240:243], v6, s[88:91], s52 offen
    buffer_load_dwordx4 v[244:247], v7, s[88:91], s52 offen offset:1024
    s_addk_i32 s79, 1024
    s_cmp_eq_u32 s79, s59
    s_cselect_b32 s79, 0, s79
    s_lshl4_add_u32 s52, s79, s81
    buffer_load_dwordx4 v[232:235], v6, s[88:91], s52 offen
    buffer_load_dwordx4 v[236:239], v7, s[88:91], s52 offen offset:1024
    s_addk_i32 s79, 1024
    s_cmp_eq_u32 s79, s59
    s_cselect_b32 s79, 0, s79
    s_lshl4_add_u32 s52, s79, s81
    buffer_load_dwordx4 v[224:227], v6, s[88:91], s52 offen
    buffer_load_dwordx4 v[228:231], v7, s[88:91], s52 offen offset:1024
    s_barrier
    ds_read_b32 v146, v4 offset:0
    ds_read_b32 v147, v4 offset:2048
    ds_read_b32 v148, v4 offset:4096
    ds_read_b32 v149, v4 offset:6144
    ds_read_b32 v150, v4 offset:1024
    ds_read_b32 v151, v4 offset:3072
    ds_read_b32 v152, v4 offset:5120
    ds_read_b32 v153, v4 offset:7168
    s_waitcnt lgkmcnt(0)
    s_barrier
    v_add_f32 v146, v146, v147
    v_add_f32 v148, v148, v149
    v_add_f32 v150, v150, v151
    v_add_f32 v152, v152, v153
    v_add_f32 v146, v146, v148
    buffer_atomic_add_f32 v146, v12, s[40:43], s69 offen
    v_add_f32 v150, v150, v152
    s_mov_b64 exec, 15
    buffer_atomic_add_f32 v150, v12, s[40:43], s69 offen offset:256
    s_mov_b64 exec, -1
    s_add_u32 s79, s80, 12288
    s_sub_u32 s52, s79, s59
    s_cselect_b32 s79, s79, s52
    s_add_u32 m0, s66, 8192
    s_lshl4_add_u32 s52, s79, s81
    buffer_load_dwordx4 v6, s[88:91], s52 offen lds
    buffer_load_dwordx4 v7, s[88:91], s52 offen offset:1024 lds
    s_addk_i32 s79, 1024
    s_cmp_eq_u32 s79, s59
    s_cselect_b32 s79, 0, s79
    s_add_u32 m0, s66, 10240
    s_lshl4_add_u32 s52, s79, s81
    buffer_load_dwordx4 v6, s[88:91], s52 offen lds
    buffer_load_dwordx4 v7, s[88:91], s52 offen offset:1024 lds
    s_addk_i32 s79, 1024
    s_cmp_eq_u32 s79, s59
    s_cselect_b32 s79, 0, s79
    s_add_u32 m0, s66, 12288
    s_lshl4_add_u32 s52, s79, s81
    buffer_load_dwordx4 v6, s[88:91], s52 offen lds
    buffer_load_dwordx4 v7, s[88:91], s52 offen offset:1024 lds
    s_addk_i32 s79, 1024
    s_cmp_eq_u32 s79, s59
    s_cselect_b32 s79, 0, s79
    s_add_u32 m0, s66, 14336
    s_lshl4_add_u32 s52, s79, s81
    buffer_load_dwordx4 v6, s[88:91], s52 offen lds
    buffer_load_dwordx4 v7, s[88:91], s52 offen offset:1024 lds
    s_waitcnt vmcnt(8)
    buffer_store_dword v5, off, s[40:43], s71 offset:384 sc1
    ds_read_b64_tr_b16 v[48:49], v8 offset:0
    ds_read_b64_tr_b16 v[50:51], v8 offset:512
    ds_read_b64_tr_b16 v[52:53], v9 offset:0
    ds_read_b64_tr_b16 v[54:55], v9 offset:512
    ds_read_b64_tr_b16 v[56:57], v8 offset:2048
    ds_read_b64_tr_b16 v[58:59], v8 offset:2560
    ds_read_b64_tr_b16 v[60:61], v9 offset:2048
    ds_read_b64_tr_b16 v[62:63], v9 offset:2560
    ds_read_b64_tr_b16 v[64:65], v8 offset:4096
    ds_read_b64_tr_b16 v[66:67], v8 offset:4608
    ds_read_b64_tr_b16 v[68:69], v9 offset:4096
    ds_read_b64_tr_b16 v[70:71], v9 offset:4608
    ds_read_b64_tr_b16 v[72:73], v8 offset:6144
    ds_read_b64_tr_b16 v[74:75], v8 offset:6656
    ds_read_b64_tr_b16 v[76:77], v9 offset:6144
    s_waitcnt lgkmcnt(14)
    ds_read_b64_tr_b16 v[78:79], v9 offset:6656
    s_add_u32 s79, s80, 16384
    s_sub_u32 s52, s79, s59
    s_cselect_b32 s79, s79, s52
    s_waitcnt lgkmcnt(0)
    s_add_u32 m0, s66, 0
    s_lshl4_add_u32 s52, s79, s81
    buffer_load_dwordx4 v6, s[88:91], s52 offen lds
    buffer_load_dwordx4 v7, s[88:91], s52 offen offset:1024 lds
    s_addk_i32 s79, 1024
    s_cmp_eq_u32 s79, s59
    s_cselect_b32 s79, 0, s79
    s_add_u32 m0, s66, 2048
    s_lshl4_add_u32 s52, s79, s81
    buffer_load_dwordx4 v6, s[88:91], s52 offen lds
    buffer_load_dwordx4 v7, s[88:91], s52 offen offset:1024 lds
    s_addk_i32 s79, 1024
    s_cmp_eq_u32 s79, s59
    s_cselect_b32 s79, 0, s79
    s_add_u32 m0, s66, 4096
    s_lshl4_add_u32 s52, s79, s81
    buffer_load_dwordx4 v6, s[88:91], s52 offen lds
    buffer_load_dwordx4 v7, s[88:91], s52 offen offset:1024 lds
    s_addk_i32 s79, 1024
    s_cmp_eq_u32 s79, s59
    s_cselect_b32 s79, 0, s79
    s_add_u32 m0, s66, 6144
    s_lshl4_add_u32 s52, s79, s81
    buffer_load_dwordx4 v6, s[88:91], s52 offen lds
    buffer_load_dwordx4 v7, s[88:91], s52 offen offset:1024 lds
    ds_read_b64_tr_b16 v[80:81], v8 offset:16384
    ds_read_b64_tr_b16 v[82:83], v8 offset:16896
    ds_read_b64_tr_b16 v[84:85], v9 offset:16384
    ds_read_b64_tr_b16 v[86:87], v9 offset:16896
    ds_read_b64_tr_b16 v[88:89], v8 offset:18432
    ds_read_b64_tr_b16 v[90:91], v8 offset:18944
    ds_read_b64_tr_b16 v[92:93], v9 offset:18432
    ds_read_b64_tr_b16 v[94:95], v9 offset:18944
    ds_read_b64_tr_b16 v[96:97], v8 offset:20480
    ds_read_b64_tr_b16 v[98:99], v8 offset:20992
    ds_read_b64_tr_b16 v[100:101], v9 offset:20480
    ds_read_b64_tr_b16 v[102:103], v9 offset:20992
    ds_read_b64_tr_b16 v[104:105], v8 offset:22528
    ds_read_b64_tr_b16 v[106:107], v8 offset:23040
    ds_read_b64_tr_b16 v[108:109], v9 offset:22528
    s_waitcnt lgkmcnt(14)
    ds_read_b64_tr_b16 v[110:111], v9 offset:23040
    s_add_u32 s79, s80, 20480
    s_sub_u32 s52, s79, s59
    s_cselect_b32 s79, s79, s52
    s_waitcnt lgkmcnt(0)
    s_add_u32 m0, s66, 16384
    s_lshl4_add_u32 s52, s79, s81
    buffer_load_dwordx4 v6, s[88:91], s52 offen lds
    buffer_load_dwordx4 v7, s[88:91], s52 offen offset:1024 lds
    s_addk_i32 s79, 1024
    s_cmp_eq_u32 s79, s59
    s_cselect_b32 s79, 0, s79
    s_add_u32 m0, s66, 18432
    s_lshl4_add_u32 s52, s79, s81
    buffer_load_dwordx4 v6, s[88:91], s52 offen lds
    buffer_load_dwordx4 v7, s[88:91], s52 offen offset:1024 lds
    s_addk_i32 s79, 1024
    s_cmp_eq_u32 s79, s59
    s_cselect_b32 s79, 0, s79
    s_add_u32 m0, s66, 20480
    s_lshl4_add_u32 s52, s79, s81
    buffer_load_dwordx4 v6, s[88:91], s52 offen lds
    buffer_load_dwordx4 v7, s[88:91], s52 offen offset:1024 lds
    s_addk_i32 s79, 1024
    s_cmp_eq_u32 s79, s59
    s_cselect_b32 s79, 0, s79
    s_add_u32 m0, s66, 22528
    s_lshl4_add_u32 s52, s79, s81
    buffer_load_dwordx4 v6, s[88:91], s52 offen lds
    buffer_load_dwordx4 v7, s[88:91], s52 offen offset:1024 lds
    s_waitcnt vmcnt(23)
    ds_read_b64_tr_b16 v[112:113], v8 offset:8192
    ds_read_b64_tr_b16 v[114:115], v8 offset:8704
    ds_read_b64_tr_b16 v[116:117], v9 offset:8192
    ds_read_b64_tr_b16 v[118:119], v9 offset:8704
    s_waitcnt vmcnt(21)
    ds_read_b64_tr_b16 v[120:121], v8 offset:10240
    ds_read_b64_tr_b16 v[122:123], v8 offset:10752
    ds_read_b64_tr_b16 v[124:125], v9 offset:10240
    ds_read_b64_tr_b16 v[126:127], v9 offset:10752
    s_waitcnt vmcnt(19)
    ds_read_b64_tr_b16 v[128:129], v8 offset:12288
    ds_read_b64_tr_b16 v[130:131], v8 offset:12800
    ds_read_b64_tr_b16 v[132:133], v9 offset:12288
    ds_read_b64_tr_b16 v[134:135], v9 offset:12800
    s_waitcnt vmcnt(17)
    ds_read_b64_tr_b16 v[136:137], v8 offset:14336
    ds_read_b64_tr_b16 v[138:139], v8 offset:14848
    ds_read_b64_tr_b16 v[140:141], v9 offset:14336
    s_waitcnt lgkmcnt(14)
    ds_read_b64_tr_b16 v[142:143], v9 offset:14848
    s_mov_b32 s64, s60
    s_mov_b32 s65, 0
    s_mov_b64 exec, s[64:65]
    buffer_load_dword v147, v3, s[40:43], s83 offen sc1
    s_mov_b64 exec, -1
    s_waitcnt lgkmcnt(14)
    ds_write_b128 v13, v[248:251] offset:8192
    s_waitcnt lgkmcnt(14)
    ds_write_b128 v13, v[252:255] offset:9216
    s_waitcnt lgkmcnt(14)
    ds_write_b128 v13, v[240:243] offset:10240
    s_waitcnt lgkmcnt(14)
    ds_write_b128 v13, v[244:247] offset:11264
    s_waitcnt lgkmcnt(14)
    ds_write_b128 v13, v[232:235] offset:12288
    s_waitcnt lgkmcnt(14)
    ds_write_b128 v13, v[236:239] offset:13312
    s_waitcnt lgkmcnt(14)
    ds_write_b128 v13, v[224:227] offset:14336
    s_waitcnt lgkmcnt(14)
    ds_write_b128 v13, v[228:231] offset:15360
    s_waitcnt lgkmcnt(0)
    s_waitcnt vmcnt(0)
    v_cmp_ne_u32 vcc, 0, v147
    s_andn2_b32 s60, s60, vcc_lo
    s_cbranch_scc0 L_FSKIP
    s_movk_i32 s57, 0x7fff
    s_mov_b32 exec_lo, s60
    s_mov_b32 exec_hi, 0
L_FPOLL:
    buffer_load_dword v4, v3, s[40:43], s83 offen sc1
    s_waitcnt vmcnt(0)
    v_cmp_ne_u32 vcc, 0, v4
    s_cmp_eq_u32 vcc_lo, s60
    s_cbranch_scc1 L_FPOLL_OK
    s_sleep 4
    s_sub_u32 s57, s57, 1
    s_cmp_lg_u32 s57, 0
    s_cbranch_scc1 L_FPOLL
L_FPOLL_OK:
    s_mov_b64 exec, -1
L_FSKIP:
    buffer_load_dwordx4 v[144:147], v1, s[40:43], s80 offen sc1
    buffer_load_dwordx4 v[148:151], v2, s[40:43], s80 offen sc1
    s_addk_i32 s80, 1024
    s_cmp_eq_u32 s80, s59
    s_cselect_b32 s80, 0, s80
    buffer_load_dwordx4 v[152:155], v1, s[40:43], s80 offen sc1
    buffer_load_dwordx4 v[156:159], v2, s[40:43], s80 offen sc1
    s_addk_i32 s80, 1024
    s_cmp_eq_u32 s80, s59
    s_cselect_b32 s80, 0, s80
    buffer_load_dwordx4 v[160:163], v1, s[40:43], s80 offen sc1
    buffer_load_dwordx4 v[164:167], v2, s[40:43], s80 offen sc1
    s_addk_i32 s80, 1024
    s_cmp_eq_u32 s80, s59
    s_cselect_b32 s80, 0, s80
    buffer_load_dwordx4 v[168:171], v1, s[40:43], s80 offen sc1
    buffer_load_dwordx4 v[172:175], v2, s[40:43], s80 offen sc1
    s_addk_i32 s80, 1024
    s_cmp_eq_u32 s80, s59
    s_cselect_b32 s80, 0, s80
    buffer_load_dwordx4 v[176:179], v1, s[40:43], s80 offen sc1
    buffer_load_dwordx4 v[180:183], v2, s[40:43], s80 offen sc1
    s_addk_i32 s80, 1024
    s_cmp_eq_u32 s80, s59
    s_cselect_b32 s80, 0, s80
    v_and_b32 v4, 14, v0
    v_lshlrev_b32 v4, 2, v4
    s_lshl_b32 s52, s77, 9
    s_lshl_b32 s53, s23, 6
    s_add_u32 s52, s52, s53
    s_add_u32 s52, s52, 0xb80000
    buffer_load_dwordx2 v[10:11], v4, s[40:43], s52 offen sc1
    v_and_b32 v184, 31, v0
    v_lshrrev_b32_e64 v185, 5, v0
    v_mul_u32_u24 v184, 80, v184
    v_lshl_add_u32 v184, v185, 4, v184
    v_add_u32_e64 v188, s66, v184
    v_bfe_u32 v184, v0, 1, 3
    s_lshl_b32 s52, s23, 3
    v_add_u32 v184, s52, v184
    v_mul_u32_u24 v189, 80, v184
    v_lshl_add_u32 v189, v185, 5, v189
    v_and_b32 v186, 1, v0
    s_movk_i32 s52, 5248
    v_mad_u32_u24 v189, v186, s52, v189
    v_bfe_u32 v187, v0, 4, 1
    v_lshl_add_u32 v190, v187, 14, v189
    v_lshl_add_u32 v189, v187, 13, v190
    v_add_u32 v190, 0x18000, v190
    v_and_b32_e64 v191, 48, v0
    v_lshl_add_u32 v191, v186, 6, v191
    v_lshl_add_u32 v191, v184, 10, v191
    v_lshlrev_b32 v185, 2, v185
    v_and_b32 v184, 7, v184
    v_xor_b32_e64 v5, v184, v185
    v_lshlrev_b32 v187, 4, v186
    s_movk_i32 s52, 0x3f80
    v_lshlrev_b32 v187, v187, s52
    v_cmp_eq_u32 vcc, 0, v5
    s_nop 1
    v_cndmask_b32 v184, 0, v187, vcc
    v_cmp_eq_u32 vcc, 1, v5
    s_nop 1
    v_cndmask_b32 v185, 0, v187, vcc
    v_cmp_eq_u32 vcc, 2, v5
    s_nop 1
    v_cndmask_b32 v186, 0, v187, vcc
    v_cmp_eq_u32 vcc, 3, v5
    s_nop 1
    v_cndmask_b32 v187, 0, v187, vcc
    s_waitcnt vmcnt(9)
    s_nop 0
    v_mfma_f32_32x32x16_bf16 v[192:207], v[16:19], v[144:147], 0
    v_mfma_f32_32x32x16_bf16 v[208:223], v[16:19], v[148:151], 0
    v_mfma_f32_32x32x16_bf16 v[224:239], v[20:23], v[144:147], 0
    v_mfma_f32_32x32x16_bf16 v[240:255], v[20:23], v[148:151], 0
    buffer_load_dwordx4 v[144:147], v1, s[40:43], s80 offen sc1
    buffer_load_dwordx4 v[148:151], v2, s[40:43], s80 offen sc1
    s_addk_i32 s80, 1024
    s_cmp_eq_u32 s80, s59
    s_cselect_b32 s80, 0, s80
    s_nop 0
    ds_read_b64_tr_b16 v[16:17], v8 offset:0
    ds_read_b64_tr_b16 v[18:19], v8 offset:512
    ds_read_b64_tr_b16 v[20:21], v9 offset:0
    ds_read_b64_tr_b16 v[22:23], v9 offset:512
    s_waitcnt vmcnt(9)
    s_nop 0
    v_mfma_f32_32x32x16_bf16 v[192:207], v[24:27], v[152:155], v[192:207]
    v_mfma_f32_32x32x16_bf16 v[208:223], v[24:27], v[156:159], v[208:223]
    v_mfma_f32_32x32x16_bf16 v[224:239], v[28:31], v[152:155], v[224:239]
    v_mfma_f32_32x32x16_bf16 v[240:255], v[28:31], v[156:159], v[240:255]
    buffer_load_dwordx4 v[152:155], v1, s[40:43], s80 offen sc1
    buffer_load_dwordx4 v[156:159], v2, s[40:43], s80 offen sc1
    s_addk_i32 s80, 1024
    s_cmp_eq_u32 s80, s59
    s_cselect_b32 s80, 0, s80
    s_nop 0
    ds_read_b64_tr_b16 v[24:25], v8 offset:2048
    ds_read_b64_tr_b16 v[26:27], v8 offset:2560
    ds_read_b64_tr_b16 v[28:29], v9 offset:2048
    ds_read_b64_tr_b16 v[30:31], v9 offset:2560
    s_waitcnt vmcnt(9)
    s_nop 0
    v_mfma_f32_32x32x16_bf16 v[192:207], v[32:35], v[160:163], v[192:207]
    v_mfma_f32_32x32x16_bf16 v[208:223], v[32:35], v[164:167], v[208:223]
    v_mfma_f32_32x32x16_bf16 v[224:239], v[36:39], v[160:163], v[224:239]
    v_mfma_f32_32x32x16_bf16 v[240:255], v[36:39], v[164:167], v[240:255]
    buffer_load_dwordx4 v[160:163], v1, s[40:43], s80 offen sc1
    buffer_load_dwordx4 v[164:167], v2, s[40:43], s80 offen sc1
    s_addk_i32 s80, 1024
    s_cmp_eq_u32 s80, s59
    s_cselect_b32 s80, 0, s80
    s_nop 0
    ds_read_b64_tr_b16 v[32:33], v8 offset:4096
    ds_read_b64_tr_b16 v[34:35], v8 offset:4608
    ds_read_b64_tr_b16 v[36:37], v9 offset:4096
    ds_read_b64_tr_b16 v[38:39], v9 offset:4608
    s_waitcnt vmcnt(9)
    s_nop 0
    v_mfma_f32_32x32x16_bf16 v[192:207], v[40:43], v[168:171], v[192:207]
    v_mfma_f32_32x32x16_bf16 v[208:223], v[40:43], v[172:175], v[208:223]
    v_mfma_f32_32x32x16_bf16 v[224:239], v[44:47], v[168:171], v[224:239]
    v_mfma_f32_32x32x16_bf16 v[240:255], v[44:47], v[172:175], v[240:255]
    buffer_load_dwordx4 v[168:171], v1, s[40:43], s80 offen sc1
    buffer_load_dwordx4 v[172:175], v2, s[40:43], s80 offen sc1
    s_addk_i32 s80, 1024
    s_cmp_eq_u32 s80, s59
    s_cselect_b32 s80, 0, s80
    s_nop 0
    ds_read_b64_tr_b16 v[40:41], v8 offset:6144
    ds_read_b64_tr_b16 v[42:43], v8 offset:6656
    ds_read_b64_tr_b16 v[44:45], v9 offset:6144
    s_waitcnt lgkmcnt(14)
    s_nop 0
    ds_read_b64_tr_b16 v[46:47], v9 offset:6656
    s_waitcnt vmcnt(9)
    s_nop 0
    v_mfma_f32_32x32x16_bf16 v[192:207], v[48:51], v[176:179], v[192:207]
    v_mfma_f32_32x32x16_bf16 v[208:223], v[48:51], v[180:183], v[208:223]
    v_mfma_f32_32x32x16_bf16 v[224:239], v[52:55], v[176:179], v[224:239]
    v_mfma_f32_32x32x16_bf16 v[240:255], v[52:55], v[180:183], v[240:255]
    buffer_load_dwordx4 v[176:179], v1, s[40:43], s80 offen sc1
    buffer_load_dwordx4 v[180:183], v2, s[40:43], s80 offen sc1
    s_addk_i32 s80, 1024
    s_cmp_eq_u32 s80, s59
    s_cselect_b32 s80, 0, s80
    s_waitcnt lgkmcnt(14)
    ds_read_b64_tr_b16 v[48:49], v8 offset:16384
    s_waitcnt lgkmcnt(14)
    s_nop 0
    ds_read_b64_tr_b16 v[50:51], v8 offset:16896
    s_waitcnt lgkmcnt(14)
    s_nop 0
    ds_read_b64_tr_b16 v[52:53], v9 offset:16384
    s_waitcnt lgkmcnt(14)
    s_nop 0
    ds_read_b64_tr_b16 v[54:55], v9 offset:16896
    s_waitcnt vmcnt(8)
    s_nop 0
    v_mfma_f32_32x32x16_bf16 v[192:207], v[56:59], v[144:147], v[192:207]
    v_mfma_f32_32x32x16_bf16 v[208:223], v[56:59], v[148:151], v[208:223]
    v_mfma_f32_32x32x16_bf16 v[224:239], v[60:63], v[144:147], v[224:239]
    v_mfma_f32_32x32x16_bf16 v[240:255], v[60:63], v[148:151], v[240:255]
    buffer_load_dwordx4 v[144:147], v1, s[40:43], s80 offen sc1
    buffer_load_dwordx4 v[148:151], v2, s[40:43], s80 offen sc1
    s_addk_i32 s80, 1024
    s_cmp_eq_u32 s80, s59
    s_cselect_b32 s80, 0, s80
    s_waitcnt lgkmcnt(14)
    ds_read_b64_tr_b16 v[56:57], v8 offset:18432
    s_waitcnt lgkmcnt(14)
    s_nop 0
    ds_read_b64_tr_b16 v[58:59], v8 offset:18944
    s_waitcnt lgkmcnt(14)
    s_nop 0
    ds_read_b64_tr_b16 v[60:61], v9 offset:18432
    s_waitcnt lgkmcnt(14)
    s_nop 0
    ds_read_b64_tr_b16 v[62:63], v9 offset:18944
    s_waitcnt vmcnt(8)
    s_nop 0
    v_mfma_f32_32x32x16_bf16 v[192:207], v[64:67], v[152:155], v[192:207]
    v_mfma_f32_32x32x16_bf16 v[208:223], v[64:67], v[156:159], v[208:223]
    v_mfma_f32_32x32x16_bf16 v[224:239], v[68:71], v[152:155], v[224:239]
    v_mfma_f32_32x32x16_bf16 v[240:255], v[68:71], v[156:159], v[240:255]
    buffer_load_dwordx4 v[152:155], v1, s[40:43], s80 offen sc1
    buffer_load_dwordx4 v[156:159], v2, s[40:43], s80 offen sc1
    s_addk_i32 s80, 1024
    s_cmp_eq_u32 s80, s59
    s_cselect_b32 s80, 0, s80
    s_waitcnt lgkmcnt(14)
    ds_read_b64_tr_b16 v[64:65], v8 offset:20480
    s_waitcnt lgkmcnt(14)
    s_nop 0
    ds_read_b64_tr_b16 v[66:67], v8 offset:20992
    s_waitcnt lgkmcnt(14)
    s_nop 0
    ds_read_b64_tr_b16 v[68:69], v9 offset:20480
    s_waitcnt lgkmcnt(14)
    s_nop 0
    ds_read_b64_tr_b16 v[70:71], v9 offset:20992
    s_waitcnt vmcnt(8)
    s_nop 0
    v_mfma_f32_32x32x16_bf16 v[192:207], v[72:75], v[160:163], v[192:207]
    v_mfma_f32_32x32x16_bf16 v[208:223], v[72:75], v[164:167], v[208:223]
    v_mfma_f32_32x32x16_bf16 v[224:239], v[76:79], v[160:163], v[224:239]
    v_mfma_f32_32x32x16_bf16 v[240:255], v[76:79], v[164:167], v[240:255]
    buffer_load_dwordx4 v[160:163], v1, s[40:43], s80 offen sc1
    buffer_load_dwordx4 v[164:167], v2, s[40:43], s80 offen sc1
    s_addk_i32 s80, 1024
    s_cmp_eq_u32 s80, s59
    s_cselect_b32 s80, 0, s80
    s_waitcnt lgkmcnt(14)
    ds_read_b64_tr_b16 v[72:73], v8 offset:22528
    s_waitcnt lgkmcnt(14)
    s_nop 0
    ds_read_b64_tr_b16 v[74:75], v8 offset:23040
    s_waitcnt lgkmcnt(14)
    s_nop 0
    ds_read_b64_tr_b16 v[76:77], v9 offset:22528
    s_waitcnt lgkmcnt(14)
    s_nop 0
    ds_read_b64_tr_b16 v[78:79], v9 offset:23040
    s_waitcnt vmcnt(8)
    s_nop 0
    v_mfma_f32_32x32x16_bf16 v[192:207], v[80:83], v[168:171], v[192:207]
    v_mfma_f32_32x32x16_bf16 v[208:223], v[80:83], v[172:175], v[208:223]
    v_mfma_f32_32x32x16_bf16 v[224:239], v[84:87], v[168:171], v[224:239]
    v_mfma_f32_32x32x16_bf16 v[240:255], v[84:87], v[172:175], v[240:255]
    buffer_load_dwordx4 v[168:171], v1, s[40:43], s80 offen sc1
    buffer_load_dwordx4 v[172:175], v2, s[40:43], s80 offen sc1
    s_addk_i32 s80, 1024
    s_cmp_eq_u32 s80, s59
    s_cselect_b32 s80, 0, s80
    s_waitcnt lgkmcnt(14)
    ds_read_b64_tr_b16 v[80:81], v8 offset:8192
    s_waitcnt lgkmcnt(14)
    s_nop 0
    ds_read_b64_tr_b16 v[82:83], v8 offset:8704
    s_waitcnt lgkmcnt(14)
    s_nop 0
    ds_read_b64_tr_b16 v[84:85], v9 offset:8192
    s_waitcnt lgkmcnt(14)
    s_nop 0
    ds_read_b64_tr_b16 v[86:87], v9 offset:8704
    s_waitcnt vmcnt(8)
    s_nop 0
    v_mfma_f32_32x32x16_bf16 v[192:207], v[88:91], v[176:179], v[192:207]
    v_mfma_f32_32x32x16_bf16 v[208:223], v[88:91], v[180:183], v[208:223]
    v_mfma_f32_32x32x16_bf16 v[224:239], v[92:95], v[176:179], v[224:239]
    v_mfma_f32_32x32x16_bf16 v[240:255], v[92:95], v[180:183], v[240:255]
    buffer_load_dwordx4 v[176:179], v1, s[40:43], s80 offen sc1
    buffer_load_dwordx4 v[180:183], v2, s[40:43], s80 offen sc1
    s_addk_i32 s80, 1024
    s_cmp_eq_u32 s80, s59
    s_cselect_b32 s80, 0, s80
    s_waitcnt lgkmcnt(14)
    ds_read_b64_tr_b16 v[88:89], v8 offset:10240
    s_waitcnt lgkmcnt(14)
    s_nop 0
    ds_read_b64_tr_b16 v[90:91], v8 offset:10752
    s_waitcnt lgkmcnt(14)
    s_nop 0
    ds_read_b64_tr_b16 v[92:93], v9 offset:10240
    s_waitcnt lgkmcnt(14)
    s_nop 0
    ds_read_b64_tr_b16 v[94:95], v9 offset:10752
    s_waitcnt vmcnt(8)
    s_nop 0
    v_mfma_f32_32x32x16_bf16 v[192:207], v[96:99], v[144:147], v[192:207]
    v_mfma_f32_32x32x16_bf16 v[208:223], v[96:99], v[148:151], v[208:223]
    v_mfma_f32_32x32x16_bf16 v[224:239], v[100:103], v[144:147], v[224:239]
    v_mfma_f32_32x32x16_bf16 v[240:255], v[100:103], v[148:151], v[240:255]
    buffer_load_dwordx4 v[144:147], v1, s[40:43], s80 offen sc1
    buffer_load_dwordx4 v[148:151], v2, s[40:43], s80 offen sc1
    s_addk_i32 s80, 1024
    s_cmp_eq_u32 s80, s59
    s_cselect_b32 s80, 0, s80
    s_waitcnt lgkmcnt(14)
    ds_read_b64_tr_b16 v[96:97], v8 offset:12288
    s_waitcnt lgkmcnt(14)
    s_nop 0
    ds_read_b64_tr_b16 v[98:99], v8 offset:12800
    s_waitcnt lgkmcnt(14)
    s_nop 0
    ds_read_b64_tr_b16 v[100:101], v9 offset:12288
    s_waitcnt lgkmcnt(14)
    s_nop 0
    ds_read_b64_tr_b16 v[102:103], v9 offset:12800
    s_waitcnt vmcnt(8)
    s_nop 0
    v_mfma_f32_32x32x16_bf16 v[192:207], v[104:107], v[152:155], v[192:207]
    v_mfma_f32_32x32x16_bf16 v[208:223], v[104:107], v[156:159], v[208:223]
    v_mfma_f32_32x32x16_bf16 v[224:239], v[108:111], v[152:155], v[224:239]
    v_mfma_f32_32x32x16_bf16 v[240:255], v[108:111], v[156:159], v[240:255]
    buffer_load_dwordx4 v[152:155], v1, s[40:43], s80 offen sc1
    buffer_load_dwordx4 v[156:159], v2, s[40:43], s80 offen sc1
    s_addk_i32 s80, 1024
    s_cmp_eq_u32 s80, s59
    s_cselect_b32 s80, 0, s80
    s_waitcnt lgkmcnt(14)
    ds_read_b64_tr_b16 v[104:105], v8 offset:14336
    s_waitcnt lgkmcnt(14)
    s_nop 0
    ds_read_b64_tr_b16 v[106:107], v8 offset:14848
    s_waitcnt lgkmcnt(14)
    s_nop 0
    ds_read_b64_tr_b16 v[108:109], v9 offset:14336
    s_waitcnt lgkmcnt(14)
    s_nop 0
    ds_read_b64_tr_b16 v[110:111], v9 offset:14848
    s_waitcnt vmcnt(8)
    s_nop 0
    v_mfma_f32_32x32x16_bf16 v[192:207], v[112:115], v[160:163], v[192:207]
    v_mfma_f32_32x32x16_bf16 v[208:223], v[112:115], v[164:167], v[208:223]
    v_mfma_f32_32x32x16_bf16 v[224:239], v[116:119], v[160:163], v[224:239]
    v_mfma_f32_32x32x16_bf16 v[240:255], v[116:119], v[164:167], v[240:255]
    buffer_load_dwordx4 v[160:163], v1, s[40:43], s80 offen sc1
    buffer_load_dwordx4 v[164:167], v2, s[40:43], s80 offen sc1
    s_addk_i32 s80, 1024
    s_cmp_eq_u32 s80, s59
    s_cselect_b32 s80, 0, s80
    s_waitcnt vmcnt(8)
    v_mfma_f32_32x32x16_bf16 v[192:207], v[120:123], v[168:171], v[192:207]
    v_mfma_f32_32x32x16_bf16 v[208:223], v[120:123], v[172:175], v[208:223]
    v_mfma_f32_32x32x16_bf16 v[224:239], v[124:127], v[168:171], v[224:239]
    v_mfma_f32_32x32x16_bf16 v[240:255], v[124:127], v[172:175], v[240:255]
    buffer_load_dwordx4 v[168:171], v1, s[40:43], s80 offen sc1
    buffer_load_dwordx4 v[172:175], v2, s[40:43], s80 offen sc1
    s_addk_i32 s80, 1024
    s_cmp_eq_u32 s80, s59
    s_cselect_b32 s80, 0, s80
    s_waitcnt vmcnt(8)
    v_mfma_f32_32x32x16_bf16 v[192:207], v[128:131], v[176:179], v[192:207]
    v_mfma_f32_32x32x16_bf16 v[208:223], v[128:131], v[180:183], v[208:223]
    v_mfma_f32_32x32x16_bf16 v[224:239], v[132:135], v[176:179], v[224:239]
    v_mfma_f32_32x32x16_bf16 v[240:255], v[132:135], v[180:183], v[240:255]
    buffer_load_dwordx4 v[176:179], v1, s[40:43], s80 offen sc1
    buffer_load_dwordx4 v[180:183], v2, s[40:43], s80 offen sc1
    s_addk_i32 s80, 1024
    s_cmp_eq_u32 s80, s59
    s_cselect_b32 s80, 0, s80
    s_waitcnt vmcnt(8)
    v_mfma_f32_32x32x16_bf16 v[192:207], v[136:139], v[144:147], v[192:207]
    v_mfma_f32_32x32x16_bf16 v[208:223], v[136:139], v[148:151], v[208:223]
    v_mfma_f32_32x32x16_bf16 v[224:239], v[140:143], v[144:147], v[224:239]
    v_mfma_f32_32x32x16_bf16 v[240:255], v[140:143], v[148:151], v[240:255]
    buffer_load_dwordx4 v[144:147], v1, s[40:43], s80 offen sc1
    buffer_load_dwordx4 v[148:151], v2, s[40:43], s80 offen sc1
    s_addk_i32 s80, 1024
    s_cmp_eq_u32 s80, s59
    s_cselect_b32 s80, 0, s80
    s_waitcnt vmcnt(8)
    v_mfma_f32_32x32x16_bf16 v[192:207], v[16:19], v[152:155], v[192:207]
    v_mfma_f32_32x32x16_bf16 v[208:223], v[16:19], v[156:159], v[208:223]
    v_mfma_f32_32x32x16_bf16 v[224:239], v[20:23], v[152:155], v[224:239]
    v_mfma_f32_32x32x16_bf16 v[240:255], v[20:23], v[156:159], v[240:255]
    buffer_load_dwordx4 v[152:155], v1, s[40:43], s80 offen sc1
    buffer_load_dwordx4 v[156:159], v2, s[40:43], s80 offen sc1
    s_addk_i32 s80, 1024
    s_cmp_eq_u32 s80, s59
    s_cselect_b32 s80, 0, s80
    s_waitcnt vmcnt(8)
    v_mfma_f32_32x32x16_bf16 v[192:207], v[24:27], v[160:163], v[192:207]
    v_mfma_f32_32x32x16_bf16 v[208:223], v[24:27], v[164:167], v[208:223]
    v_mfma_f32_32x32x16_bf16 v[224:239], v[28:31], v[160:163], v[224:239]
    v_mfma_f32_32x32x16_bf16 v[240:255], v[28:31], v[164:167], v[240:255]
    buffer_load_dwordx4 v[160:163], v1, s[40:43], s80 offen sc1
    buffer_load_dwordx4 v[164:167], v2, s[40:43], s80 offen sc1
    s_addk_i32 s80, 1024
    s_cmp_eq_u32 s80, s59
    s_cselect_b32 s80, 0, s80
    s_waitcnt vmcnt(8)
    v_mfma_f32_32x32x16_bf16 v[192:207], v[32:35], v[168:171], v[192:207]
    v_mfma_f32_32x32x16_bf16 v[208:223], v[32:35], v[172:175], v[208:223]
    v_mfma_f32_32x32x16_bf16 v[224:239], v[36:39], v[168:171], v[224:239]
    v_mfma_f32_32x32x16_bf16 v[240:255], v[36:39], v[172:175], v[240:255]
    buffer_load_dwordx4 v[168:171], v1, s[40:43], s80 offen sc1
    buffer_load_dwordx4 v[172:175], v2, s[40:43], s80 offen sc1
    s_addk_i32 s80, 1024
    s_cmp_eq_u32 s80, s59
    s_cselect_b32 s80, 0, s80
    s_waitcnt vmcnt(8)
    v_mfma_f32_32x32x16_bf16 v[192:207], v[40:43], v[176:179], v[192:207]
    v_mfma_f32_32x32x16_bf16 v[208:223], v[40:43], v[180:183], v[208:223]
    v_mfma_f32_32x32x16_bf16 v[224:239], v[44:47], v[176:179], v[224:239]
    v_mfma_f32_32x32x16_bf16 v[240:255], v[44:47], v[180:183], v[240:255]
    buffer_load_dwordx4 v[176:179], v1, s[40:43], s80 offen sc1
    buffer_load_dwordx4 v[180:183], v2, s[40:43], s80 offen sc1
    s_addk_i32 s80, 1024
    s_cmp_eq_u32 s80, s59
    s_cselect_b32 s80, 0, s80
    s_waitcnt vmcnt(8)
    v_mfma_f32_32x32x16_bf16 v[192:207], v[48:51], v[144:147], v[192:207]
    v_mfma_f32_32x32x16_bf16 v[208:223], v[48:51], v[148:151], v[208:223]
    v_mfma_f32_32x32x16_bf16 v[224:239], v[52:55], v[144:147], v[224:239]
    v_mfma_f32_32x32x16_bf16 v[240:255], v[52:55], v[148:151], v[240:255]
    buffer_load_dwordx4 v[144:147], v1, s[40:43], s80 offen sc1
    buffer_load_dwordx4 v[148:151], v2, s[40:43], s80 offen sc1
    s_addk_i32 s80, 1024
    s_cmp_eq_u32 s80, s59
    s_cselect_b32 s80, 0, s80
    s_waitcnt vmcnt(8)
    v_mfma_f32_32x32x16_bf16 v[192:207], v[56:59], v[152:155], v[192:207]
    v_mfma_f32_32x32x16_bf16 v[208:223], v[56:59], v[156:159], v[208:223]
    v_mfma_f32_32x32x16_bf16 v[224:239], v[60:63], v[152:155], v[224:239]
    v_mfma_f32_32x32x16_bf16 v[240:255], v[60:63], v[156:159], v[240:255]
    buffer_load_dwordx4 v[152:155], v1, s[40:43], s80 offen sc1
    buffer_load_dwordx4 v[156:159], v2, s[40:43], s80 offen sc1
    s_addk_i32 s80, 1024
    s_cmp_eq_u32 s80, s59
    s_cselect_b32 s80, 0, s80
    s_waitcnt vmcnt(8)
    v_mfma_f32_32x32x16_bf16 v[192:207], v[64:67], v[160:163], v[192:207]
    v_mfma_f32_32x32x16_bf16 v[208:223], v[64:67], v[164:167], v[208:223]
    v_mfma_f32_32x32x16_bf16 v[224:239], v[68:71], v[160:163], v[224:239]
    v_mfma_f32_32x32x16_bf16 v[240:255], v[68:71], v[164:167], v[240:255]
    buffer_load_dwordx4 v[160:163], v1, s[40:43], s80 offen sc1
    buffer_load_dwordx4 v[164:167], v2, s[40:43], s80 offen sc1
    s_addk_i32 s80, 1024
    s_cmp_eq_u32 s80, s59
    s_cselect_b32 s80, 0, s80
    s_waitcnt vmcnt(8)
    v_mfma_f32_32x32x16_bf16 v[192:207], v[72:75], v[168:171], v[192:207]
    v_mfma_f32_32x32x16_bf16 v[208:223], v[72:75], v[172:175], v[208:223]
    v_mfma_f32_32x32x16_bf16 v[224:239], v[76:79], v[168:171], v[224:239]
    v_mfma_f32_32x32x16_bf16 v[240:255], v[76:79], v[172:175], v[240:255]
    s_waitcnt vmcnt(6)
    s_waitcnt lgkmcnt(14)
    v_mfma_f32_32x32x16_bf16 v[192:207], v[80:83], v[176:179], v[192:207]
    v_mfma_f32_32x32x16_bf16 v[208:223], v[80:83], v[180:183], v[208:223]
    s_waitcnt lgkmcnt(12)
    s_nop 0
    v_mfma_f32_32x32x16_bf16 v[224:239], v[84:87], v[176:179], v[224:239]
    v_mfma_f32_32x32x16_bf16 v[240:255], v[84:87], v[180:183], v[240:255]
    s_waitcnt vmcnt(4)
    s_waitcnt lgkmcnt(10)
    v_mfma_f32_32x32x16_bf16 v[192:207], v[88:91], v[144:147], v[192:207]
    v_mfma_f32_32x32x16_bf16 v[208:223], v[88:91], v[148:151], v[208:223]
    s_waitcnt lgkmcnt(8)
    s_nop 0
    v_mfma_f32_32x32x16_bf16 v[224:239], v[92:95], v[144:147], v[224:239]
    v_mfma_f32_32x32x16_bf16 v[240:255], v[92:95], v[148:151], v[240:255]
    s_waitcnt vmcnt(2)
    s_waitcnt lgkmcnt(6)
    v_mfma_f32_32x32x16_bf16 v[192:207], v[96:99], v[152:155], v[192:207]
    v_mfma_f32_32x32x16_bf16 v[208:223], v[96:99], v[156:159], v[208:223]
    s_waitcnt lgkmcnt(4)
    s_nop 0
    v_mfma_f32_32x32x16_bf16 v[224:239], v[100:103], v[152:155], v[224:239]
    v_mfma_f32_32x32x16_bf16 v[240:255], v[100:103], v[156:159], v[240:255]
    s_waitcnt vmcnt(0)
    s_waitcnt lgkmcnt(2)
    v_mfma_f32_32x32x16_bf16 v[192:207], v[104:107], v[160:163], v[192:207]
    v_mfma_f32_32x32x16_bf16 v[208:223], v[104:107], v[164:167], v[208:223]
    s_waitcnt lgkmcnt(0)
    s_nop 0
    v_mfma_f32_32x32x16_bf16 v[224:239], v[108:111], v[160:163], v[224:239]
    v_mfma_f32_32x32x16_bf16 v[240:255], v[108:111], v[164:167], v[240:255]
    s_nop 7
    v_cvt_pk_bf16_f32 v192, v192, v193
    v_cvt_pk_bf16_f32 v193, v194, v195
    v_cvt_pk_bf16_f32 v194, v196, v197
    v_cvt_pk_bf16_f32 v195, v198, v199
    ds_write_b128 v188, v[192:195] offset:0
    v_cvt_pk_bf16_f32 v200, v200, v201
    v_cvt_pk_bf16_f32 v201, v202, v203
    v_cvt_pk_bf16_f32 v202, v204, v205
    v_cvt_pk_bf16_f32 v203, v206, v207
    ds_write_b128 v188, v[200:203] offset:32
    v_cvt_pk_bf16_f32 v208, v208, v209
    v_cvt_pk_bf16_f32 v209, v210, v211
    v_cvt_pk_bf16_f32 v210, v212, v213
    v_cvt_pk_bf16_f32 v211, v214, v215
    ds_write_b128 v188, v[208:211] offset:2560
    v_cvt_pk_bf16_f32 v216, v216, v217
    v_cvt_pk_bf16_f32 v217, v218, v219
    v_cvt_pk_bf16_f32 v218, v220, v221
    v_cvt_pk_bf16_f32 v219, v222, v223
    ds_write_b128 v188, v[216:219] offset:2592
    v_cvt_pk_bf16_f32 v224, v224, v225
    v_cvt_pk_bf16_f32 v225, v226, v227
    v_cvt_pk_bf16_f32 v226, v228, v229
    v_cvt_pk_bf16_f32 v227, v230, v231
    ds_write_b128 v188, v[224:227] offset:5248
    v_cvt_pk_bf16_f32 v232, v232, v233
    v_cvt_pk_bf16_f32 v233, v234, v235
    v_cvt_pk_bf16_f32 v234, v236, v237
    v_cvt_pk_bf16_f32 v235, v238, v239
    ds_write_b128 v188, v[232:235] offset:5280
    v_cvt_pk_bf16_f32 v240, v240, v241
    v_cvt_pk_bf16_f32 v241, v242, v243
    v_cvt_pk_bf16_f32 v242, v244, v245
    v_cvt_pk_bf16_f32 v243, v246, v247
    ds_write_b128 v188, v[240:243] offset:7808
    v_cvt_pk_bf16_f32 v248, v248, v249
    v_cvt_pk_bf16_f32 v249, v250, v251
    v_cvt_pk_bf16_f32 v250, v252, v253
    v_cvt_pk_bf16_f32 v251, v254, v255
    ds_write_b128 v188, v[248:251] offset:7840
L_RED:
    s_lshl_b32 s66, s77, 16
    s_lshl_b32 s52, s78, 7
    s_add_u32 s66, s66, s52
    s_waitcnt vmcnt(0) lgkmcnt(0)
    s_barrier
    ds_read_b128 v[64:67], v189 offset:0
    ds_read_b128 v[68:71], v189 offset:16
    ds_read_b128 v[72:75], v189 offset:49152
    ds_read_b128 v[76:79], v189 offset:49168
    ds_read_b128 v[80:83], v190 offset:0
    ds_read_b128 v[84:87], v190 offset:16
    ds_read_b128 v[88:91], v190 offset:32768
    ds_read_b128 v[92:95], v190 offset:32784
    s_waitcnt lgkmcnt(7)
    v_mfma_f32_16x16x32_bf16 v[96:99], v[184:187], v[64:67], 0
    s_waitcnt lgkmcnt(6)
    v_mfma_f32_16x16x32_bf16 v[100:103], v[184:187], v[68:71], 0
    s_waitcnt lgkmcnt(5)
    v_mfma_f32_16x16x32_bf16 v[96:99], v[184:187], v[72:75], v[96:99]
    s_waitcnt lgkmcnt(4)
    v_mfma_f32_16x16x32_bf16 v[100:103], v[184:187], v[76:79], v[100:103]
    s_waitcnt lgkmcnt(3)
    v_mfma_f32_16x16x32_bf16 v[104:107], v[184:187], v[80:83], 0
    s_waitcnt lgkmcnt(2)
    v_mfma_f32_16x16x32_bf16 v[108:111], v[184:187], v[84:87], 0
    s_waitcnt lgkmcnt(1)
    v_mfma_f32_16x16x32_bf16 v[104:107], v[184:187], v[88:91], v[104:107]
    s_waitcnt lgkmcnt(0)
    v_mfma_f32_16x16x32_bf16 v[108:111], v[184:187], v[92:95], v[108:111]
    v_mul_f32 v96, v96, v11
    v_mul_f32 v97, v97, v11
    v_mul_f32 v98, v98, v11
    v_mul_f32 v99, v99, v11
    v_mul_f32 v100, v100, v11
    v_mul_f32 v101, v101, v11
    v_mul_f32 v102, v102, v11
    v_mul_f32 v103, v103, v11
    v_fmac_f32 v96, v104, v10
    v_fmac_f32 v97, v105, v10
    v_cvt_pk_bf16_f32 v64, v96, v97
    v_fmac_f32 v98, v106, v10
    v_fmac_f32 v99, v107, v10
    v_cvt_pk_bf16_f32 v65, v98, v99
    v_fmac_f32 v100, v108, v10
    v_fmac_f32 v101, v109, v10
    v_cvt_pk_bf16_f32 v66, v100, v101
    v_fmac_f32 v102, v110, v10
    v_fmac_f32 v103, v111, v10
    v_cvt_pk_bf16_f32 v67, v102, v103
    buffer_store_dwordx4 v[64:67], v191, s[92:95], s66 offen
L_END:
    s_endpgm
    s_nop 0
    s_nop 0
    s_nop 0
    s_nop 0
    s_nop 0
    s_nop 0
    s_nop 0
    s_nop 0
    s_nop 0
    s_nop 0
    s_nop 0
    s_nop 0
    s_nop 0
    s_nop 0
    s_nop 0
L_COMPUTE:
    v_and_b32 v8, 15, v0
    v_lshrrev_b32 v14, 4, v0
    v_lshrrev_b32 v9, 5, v0
    v_bfe_u32 v10, v0, 1, 3
    v_xor_b32 v10, v10, v14
    v_lshlrev_b32 v10, 4, v10
    v_lshl_add_u32 v10, v8, 7, v10
    s_mul_i32 s52, s22, 24576
    v_add_u32 v1, s52, v10
    v_xor_b32 v2, 64, v1
    v_bfe_u32 v10, v0, 2, 2
    v_lshl_add_u32 v10, v14, 3, v10
    v_and_b32 v11, 3, v0
    v_bfe_u32 v12, v0, 4, 1
    v_and_b32 v13, 2, v0
    v_lshrrev_b32 v4, 1, v0
    v_and_b32 v4, 4, v4
    v_or3_b32 v13, v13, v4, v12
    v_and_b32 v4, 1, v0
    v_lshlrev_b32 v4, 3, v4
    v_lshl_add_u32 v13, v13, 4, v4
    v_lshl_add_u32 v13, v10, 7, v13
    v_add_u32 v3, 0x18000, v13
    v_xor_b32 v4, 16, v3
    v_xor_b32 v5, 64, v3
    v_xor_b32 v6, 80, v3
    v_lshlrev_b32 v13, 3, v11
    v_lshl_add_u32 v13, v12, 5, v13
    v_lshl_add_u32 v13, v10, 6, v13
    v_add_u32 v7, 0x1c000, v13
    v_lshlrev_b32 v8, 4, v0
    s_waitcnt lgkmcnt(0)
    s_cmp_lt_u32 s21, 28
    s_cselect_b32 s28, s8, s6
    s_cselect_b32 s29, s9, s7
    s_cselect_b32 s32, s10, s6
    s_cselect_b32 s33, s11, s7
    s_and_b32 s29, s29, 0xffff
    s_and_b32 s33, s33, 0xffff
    s_mov_b32 s36, s6
    s_and_b32 s37, s7, 0xffff
    s_mov_b32 s24, s4
    s_and_b32 s25, s5, 0xffff
    s_mov_b32 s40, s18
    s_and_b32 s41, s19, 0xffff
    s_mov_b32 s42, 0x2000000
    s_mov_b32 s43, 0x20000
    s_mov_b32 s44, s16
    s_and_b32 s45, s17, 0xffff
    s_mov_b32 s46, 0x100
    s_mov_b32 s47, 0x20000
    s_mov_b32 s48, s14
    s_and_b32 s49, s15, 0xffff
    s_mov_b32 s50, 0x400
    s_mov_b32 s51, 0x20000
    s_mov_b32 s88, s12
    s_and_b32 s89, s13, 0xffff
    s_mov_b32 s90, 0x1c0000
    s_mov_b32 s91, 0x20000
    s_mov_b32 s92, s84
    s_and_b32 s93, s85, 0xffff
    s_mov_b32 s94, 0x200000
    s_mov_b32 s95, 0x20000
    s_mov_b32 s96, s86
    s_and_b32 s97, s87, 0xffff
    s_mov_b32 s98, 0x80000
    s_mov_b32 s99, 0x20000
    s_lshl_b32 s4, s3, 14
    s_add_u32 s4, s4, 0xb00000
    s_add_u32 s5, s4, 3072
    s_add_u32 s6, s4, 6144
    s_add_u32 s7, s4, 9216
    s_or_b32 s75, s20, s22
    s_cmp_lg_u32 s75, 0
    s_cbranch_scc1 L_NOZERO
    v_mov_b32 v16, 0
    v_mov_b32 v17, 0
    v_mov_b32 v18, 0
    v_mov_b32 v19, 0
    v_mov_b32 v22, 0
    v_mov_b32 v23, 0
    s_lshl_b32 s53, s21, 11
    s_add_u32 s53, s53, 0xb00000
    buffer_store_dwordx4 v[16:19], v8, s[40:43], s53 offen offset:0 sc0 sc1
    buffer_store_dwordx4 v[16:19], v8, s[40:43], s53 offen offset:1024 sc0 sc1
    v_and_b32 v20, 31, v0
    v_lshlrev_b32 v20, 6, v20
    s_lshl_b32 s53, s21, 11
    s_add_u32 s53, s53, 0xb90000
    s_mov_b32 exec_hi, 0
    buffer_store_dwordx2 v[22:23], v20, s[40:43], s53 offen sc0 sc1
    s_mov_b32 exec_hi, -1
L_NOZERO:
    s_lshl_b32 s76, s20, 8
    s_lshl3_add_u32 s76, s21, s76
    s_lshl1_add_u32 s76, s22, s76
    s_lshl_b32 s52, s76, 10
    buffer_load_dwordx4 v[24:27], v8, s[48:51], 0 offen
    buffer_load_dwordx4 v[28:31], v8, s[24:27], s52 offen
    buffer_load_dwordx4 v[32:35], v8, s[24:27], s52 offen offset:1024
    s_and_b32 s82, s82, 0xffffff00
    s_lshr_b32 s52, s2, 3
    s_lshl2_add_u32 s52, s52, s22
    s_lshl_b32 s52, s52, 8
    v_and_b32 v60, 1, v0
    v_lshlrev_b32 v60, 7, v60
    v_add_u32 v60, s52, v60
    v_min_u32 v60, 0x5854, v60
    global_load_dword v89, v60, s[82:83]
    s_lshl_b32 s54, s20, 3
    s_lshl_b32 s55, s22, 1
    s_add_u32 s54, s54, s55
    s_mul_i32 s60, s54, 114688
    s_lshl_b32 s56, s21, 12
    s_add_u32 s60, s60, s56
    s_add_u32 s61, s60, 114688
    s_lshl_b32 s54, s54, 15
    s_sub_u32 s56, s21, 28
    s_lshl_b32 s56, s56, 13
    s_add_u32 s62, s54, s56
    s_add_u32 s62, s62, 0x700000
    s_add_u32 s63, s62, 4096
    s_add_u32 s64, s62, 32768
    s_add_u32 s65, s64, 4096
    s_lshl_b32 s16, s3, 10
    s_add_u32 s16, s16, s54
    s_add_u32 s18, s16, 0x900000
    s_add_u32 s19, s18, 32768
    s_add_u32 s16, s16, 0x700000
    s_add_u32 s17, s16, 32768
    s_lshl2_add_u32 s54, s20, s22
    s_lshl_b32 s54, s54, 11
    s_add_u32 s54, s54, 0xb90000
    s_lshl_b32 s66, s21, 6
    s_add_u32 s66, s66, s54
    s_lshl_b32 s79, s3, 6
    s_add_u32 s79, s79, s54
    s_lshr_b32 s80, s3, 3
    s_add_u32 s80, s80, 28
    s_lshl_b32 s80, s80, 6
    s_add_u32 s80, s80, s54
    v_and_b32 v10, 15, v0
    v_lshlrev_b32 v10, 4, v10
    v_lshl_add_u32 v13, v12, 2, v9
    s_movk_i32 s55, 384
    v_mad_u32_u24 v10, v13, s55, v10
    v_bfe_u32 v12, v0, 3, 1
    v_lshl_add_u32 v12, v12, 2, v11
    v_lshl_add_u32 v12, v12, 2, v9
    v_mul_u32_u24 v12, s55, v12
    v_and_b32 v13, 15, v0
    v_lshlrev_b32 v13, 4, v13
    v_lshl_add_u32 v13, v14, 9, v13
    v_xor_b32 v14, 32, v7
    s_lshl_b32 s54, s22, 11
    s_add_u32 s54, s54, 0x22000
    v_add_u32 v9, s54, v8
    v_mov_b32 v80, 0x3f803f80
    v_mov_b32 v81, 0x3f803f80
    v_mov_b32 v82, 0x3f803f80
    v_mov_b32 v83, 0x3f803f80
    v_mov_b32 v11, 1
    s_mov_b32 s67, 0x3fb8aa3b
    s_mov_b32 s68, 0x358637bd
    s_mov_b32 s69, 0xffff0000
    s_movk_i32 s70, 8192
    s_movk_i32 s71, -16384
    s_movk_i32 s72, 20480
    s_mov_b32 s73, -40960
    s_mov_b32 s59, 0
    s_mov_b32 s74, 7
    s_and_b32 s53, s77, 3
    s_lshl1_add_u32 s56, s53, s78
    s_add_u32 s57, s56, 0
    s_and_b32 s57, s57, 7
    s_lshl_b32 s8, s57, 10
    s_add_u32 s57, s56, 1
    s_and_b32 s57, s57, 7
    s_lshl_b32 s9, s57, 10
    s_add_u32 s57, s56, 2
    s_and_b32 s57, s57, 7
    s_lshl_b32 s10, s57, 10
    s_add_u32 s57, s56, 3
    s_and_b32 s57, s57, 7
    s_lshl_b32 s11, s57, 10
    s_add_u32 s57, s56, 4
    s_and_b32 s57, s57, 7
    s_lshl_b32 s12, s57, 10
    s_add_u32 s57, s56, 5
    s_and_b32 s57, s57, 7
    s_lshl_b32 s13, s57, 10
    s_add_u32 s57, s56, 6
    s_and_b32 s57, s57, 7
    s_lshl_b32 s14, s57, 10
    s_add_u32 s57, s56, 7
    s_and_b32 s57, s57, 7
    s_lshl_b32 s15, s57, 10
    s_waitcnt vmcnt(1)
    s_cmp_lg_u32 s75, 0
    s_cbranch_scc1 L_NOFLAG
    s_lshl_b32 s52, s21, 2
    buffer_store_dword v11, off, s[44:47], s52 sc0 sc1
L_NOFLAG:
    v_lshlrev_b32 v36, 16, v24
    v_and_b32 v37, s69, v24
    v_lshlrev_b32 v38, 16, v25
    v_and_b32 v39, s69, v25
    v_lshlrev_b32 v40, 16, v26
    v_and_b32 v41, s69, v26
    v_lshlrev_b32 v42, 16, v27
    v_and_b32 v43, s69, v27
    v_lshlrev_b32 v44, 16, v28
    v_and_b32 v45, s69, v28
    v_lshlrev_b32 v46, 16, v29
    v_and_b32 v47, s69, v29
    v_lshlrev_b32 v48, 16, v30
    v_and_b32 v49, s69, v30
    v_lshlrev_b32 v50, 16, v31
    v_and_b32 v51, s69, v31
    v_pk_mul_f32 v[44:45], v[44:45], v[36:37]
    v_pk_mul_f32 v[46:47], v[46:47], v[38:39]
    v_pk_mul_f32 v[48:49], v[48:49], v[40:41]
    v_pk_mul_f32 v[50:51], v[50:51], v[42:43]
    v_cvt_pk_bf16_f32 v44, v44, v45
    v_cvt_pk_bf16_f32 v45, v46, v47
    v_cvt_pk_bf16_f32 v46, v48, v49
    v_cvt_pk_bf16_f32 v47, v50, v51
    v_dot2_f32_bf16 v52, v44, v80, 0
    v_dot2_f32_bf16 v52, v45, v80, v52
    v_dot2_f32_bf16 v52, v46, v80, v52
    v_dot2_f32_bf16 v52, v47, v80, v52
    v_lshlrev_b32 v44, 16, v32
    v_and_b32 v45, s69, v32
    v_lshlrev_b32 v46, 16, v33
    v_and_b32 v47, s69, v33
    v_lshlrev_b32 v48, 16, v34
    v_and_b32 v49, s69, v34
    v_lshlrev_b32 v50, 16, v35
    v_and_b32 v51, s69, v35
    v_pk_mul_f32 v[44:45], v[44:45], v[36:37]
    v_pk_mul_f32 v[46:47], v[46:47], v[38:39]
    v_pk_mul_f32 v[48:49], v[48:49], v[40:41]
    v_pk_mul_f32 v[50:51], v[50:51], v[42:43]
    v_cvt_pk_bf16_f32 v44, v44, v45
    v_cvt_pk_bf16_f32 v45, v46, v47
    v_cvt_pk_bf16_f32 v46, v48, v49
    v_cvt_pk_bf16_f32 v47, v50, v51
    v_dot2_f32_bf16 v53, v44, v80, 0
    v_dot2_f32_bf16 v53, v45, v80, v53
    v_dot2_f32_bf16 v53, v46, v80, v53
    v_dot2_f32_bf16 v53, v47, v80, v53
    s_nop 3
    v_permlane32_swap_b32 v52, v53
    s_nop 0
    v_add_f32 v52, v52, v53
    s_nop 1
    v_add_f32_dpp v52, v52, v52 quad_perm:[1,0,3,2] row_mask:0xf bank_mask:0xf
    s_nop 1
    v_add_f32_dpp v52, v52, v52 quad_perm:[2,3,0,1] row_mask:0xf bank_mask:0xf
    s_nop 1
    v_add_f32_dpp v52, v52, v52 row_half_mirror row_mask:0xf bank_mask:0xf
    s_nop 1
    v_add_f32_dpp v52, v52, v52 row_mirror row_mask:0xf bank_mask:0xf
    v_mov_b32 v53, v52
    s_nop 1
    v_permlane16_swap_b32 v52, v53
    s_nop 0
    v_add_f32 v52, v52, v53
    v_cvt_pk_bf16_f32 v32, v52, v52
    v_lshlrev_b32 v32, 16, v32
    v_mul_f32 v32, 0xbfb8aa3b, v32
    v_exp_f32 v32, v32
    s_nop 0
    v_add_f32 v32, 1.0, v32
    v_rcp_f32 v32, v32
    s_nop 0
    v_cvt_pk_bf16_f32 v32, v32, v32
    v_lshlrev_b32 v32, 16, v32
    v_sub_f32 v33, 1.0, v32
    v_cvt_pk_bf16_f32 v33, v33, v33
    v_lshlrev_b32 v33, 16, v33
    v_lshrrev_b32 v34, 2, v0
    s_lshl_b32 s52, s76, 3
    s_add_u32 s52, s52, 0xb80000
    s_mov_b32 exec_lo, 1
    s_mov_b32 exec_hi, 1
    buffer_store_dwordx2 v[32:33], v34, s[40:43], s52 offen sc1
    s_mov_b64 exec, -1
    s_barrier
    s_nop 0
    ds_read_b128 v[16:19], v1 offset:0
    ds_read_b64_tr_b16 v[32:33], v7 offset:0
    ds_read_b64_tr_b16 v[34:35], v7 offset:256
    ds_read_b64_tr_b16 v[36:37], v14 offset:0
    ds_read_b64_tr_b16 v[38:39], v14 offset:256
    ds_read_b128 v[20:23], v1 offset:2048
    ds_read_b64_tr_b16 v[40:41], v3 offset:0
    ds_read_b64_tr_b16 v[42:43], v3 offset:512
    ds_read_b64_tr_b16 v[44:45], v4 offset:0
    ds_read_b64_tr_b16 v[46:47], v4 offset:512
    ds_read_b64_tr_b16 v[48:49], v3 offset:8192
    ds_read_b64_tr_b16 v[50:51], v3 offset:8704
    ds_read_b128 v[24:27], v1 offset:4096
    ds_read_b128 v[28:31], v1 offset:6144
    s_waitcnt lgkmcnt(2)
    s_nop 0
    v_mfma_f32_16x16x32_bf16 v[224:227], v[16:19], v[32:35], 0
    ds_read_b64_tr_b16 v[52:53], v4 offset:8192
    v_mfma_f32_16x16x32_bf16 v[240:243], v[16:19], v[36:39], 0
    ds_read_b64_tr_b16 v[54:55], v4 offset:8704
    v_mfma_f32_16x16x32_bf16 v[96:99], v[40:43], v[16:19], 0
    ds_read_b64_tr_b16 v[56:57], v5 offset:0
    v_mfma_f32_16x16x32_bf16 v[112:115], v[44:47], v[16:19], 0
    ds_read_b64_tr_b16 v[58:59], v5 offset:512
    v_mfma_f32_16x16x32_bf16 v[160:163], v[48:51], v[16:19], 0
    ds_read_b64_tr_b16 v[60:61], v6 offset:0
    v_mfma_f32_16x16x32_bf16 v[228:231], v[20:23], v[32:35], 0
    ds_read_b64_tr_b16 v[62:63], v6 offset:512
    v_mfma_f32_16x16x32_bf16 v[244:247], v[20:23], v[36:39], 0
    ds_read_b64_tr_b16 v[64:65], v5 offset:8192
    v_mfma_f32_16x16x32_bf16 v[100:103], v[40:43], v[20:23], 0
    ds_read_b64_tr_b16 v[66:67], v5 offset:8704
    v_mfma_f32_16x16x32_bf16 v[116:119], v[44:47], v[20:23], 0
    ds_read_b64_tr_b16 v[68:69], v6 offset:8192
    v_mfma_f32_16x16x32_bf16 v[164:167], v[48:51], v[20:23], 0
    ds_read_b64_tr_b16 v[70:71], v6 offset:8704
    s_waitcnt lgkmcnt(10)
    s_nop 0
    v_mfma_f32_16x16x32_bf16 v[232:235], v[24:27], v[32:35], 0
    v_mfma_f32_16x16x32_bf16 v[248:251], v[24:27], v[36:39], 0
    v_mfma_f32_16x16x32_bf16 v[104:107], v[40:43], v[24:27], 0
    v_mfma_f32_16x16x32_bf16 v[120:123], v[44:47], v[24:27], 0
    v_mfma_f32_16x16x32_bf16 v[168:171], v[48:51], v[24:27], 0
    v_mfma_f32_16x16x32_bf16 v[236:239], v[28:31], v[32:35], 0
    v_mfma_f32_16x16x32_bf16 v[252:255], v[28:31], v[36:39], 0
    v_mfma_f32_16x16x32_bf16 v[108:111], v[40:43], v[28:31], 0
    v_mfma_f32_16x16x32_bf16 v[124:127], v[44:47], v[28:31], 0
    v_mfma_f32_16x16x32_bf16 v[172:175], v[48:51], v[28:31], 0
    s_waitcnt lgkmcnt(0)
    s_nop 0
    v_mfma_f32_16x16x32_bf16 v[176:179], v[52:55], v[16:19], 0
    ds_read_b64_tr_b16 v[32:33], v7 offset:2048
    v_mfma_f32_16x16x32_bf16 v[128:131], v[56:59], v[16:19], 0
    ds_read_b64_tr_b16 v[34:35], v7 offset:2304
    v_mfma_f32_16x16x32_bf16 v[144:147], v[60:63], v[16:19], 0
    ds_read_b64_tr_b16 v[36:37], v14 offset:2048
    v_mfma_f32_16x16x32_bf16 v[192:195], v[64:67], v[16:19], 0
    ds_read_b64_tr_b16 v[38:39], v14 offset:2304
    v_mfma_f32_16x16x32_bf16 v[208:211], v[68:71], v[16:19], 0
    ds_read_b128 v[16:19], v2 offset:0
    v_mfma_f32_16x16x32_bf16 v[180:183], v[52:55], v[20:23], 0
    ds_read_b64_tr_b16 v[40:41], v3 offset:4096
    v_mfma_f32_16x16x32_bf16 v[132:135], v[56:59], v[20:23], 0
    ds_read_b64_tr_b16 v[42:43], v3 offset:4608
    v_mfma_f32_16x16x32_bf16 v[148:151], v[60:63], v[20:23], 0
    ds_read_b64_tr_b16 v[44:45], v4 offset:4096
    v_mfma_f32_16x16x32_bf16 v[196:199], v[64:67], v[20:23], 0
    ds_read_b64_tr_b16 v[46:47], v4 offset:4608
    v_mfma_f32_16x16x32_bf16 v[212:215], v[68:71], v[20:23], 0
    ds_read_b128 v[20:23], v2 offset:2048
    v_mfma_f32_16x16x32_bf16 v[184:187], v[52:55], v[24:27], 0
    ds_read_b64_tr_b16 v[48:49], v3 offset:12288
    v_mfma_f32_16x16x32_bf16 v[136:139], v[56:59], v[24:27], 0
    ds_read_b64_tr_b16 v[50:51], v3 offset:12800
    v_mfma_f32_16x16x32_bf16 v[152:155], v[60:63], v[24:27], 0
    s_add_u32 s59, s59, 1
    s_nop 0
    v_mfma_f32_16x16x32_bf16 v[200:203], v[64:67], v[24:27], 0
    s_cmp_eq_u32 s59, 3
    s_nop 0
    v_mfma_f32_16x16x32_bf16 v[216:219], v[68:71], v[24:27], 0
    ds_read_b128 v[24:27], v2 offset:4096
    v_mfma_f32_16x16x32_bf16 v[188:191], v[52:55], v[28:31], 0
    s_cselect_b32 s59, 0, s59
    s_nop 0
    v_mfma_f32_16x16x32_bf16 v[140:143], v[56:59], v[28:31], 0
    s_cselect_b32 s56, s71, s70
    s_nop 0
    v_mfma_f32_16x16x32_bf16 v[156:159], v[60:63], v[28:31], 0
    s_cselect_b32 s57, s73, s72
    s_nop 0
    v_mfma_f32_16x16x32_bf16 v[204:207], v[64:67], v[28:31], 0
    v_mfma_f32_16x16x32_bf16 v[220:223], v[68:71], v[28:31], 0
    ds_read_b128 v[28:31], v2 offset:6144
    s_branch L_KS1
    s_nop 0
    s_nop 0
    s_nop 0
L_LOOP:
    s_waitcnt lgkmcnt(2)
    s_nop 0
    v_mfma_f32_16x16x32_bf16 v[224:227], v[16:19], v[32:35], v[224:227]
    ds_read_b64_tr_b16 v[52:53], v4 offset:8192
    v_mfma_f32_16x16x32_bf16 v[240:243], v[16:19], v[36:39], v[240:243]
    ds_read_b64_tr_b16 v[54:55], v4 offset:8704
    v_mfma_f32_16x16x32_bf16 v[96:99], v[40:43], v[16:19], v[96:99]
    ds_read_b64_tr_b16 v[56:57], v5 offset:0
    v_mfma_f32_16x16x32_bf16 v[112:115], v[44:47], v[16:19], v[112:115]
    ds_read_b64_tr_b16 v[58:59], v5 offset:512
    v_mfma_f32_16x16x32_bf16 v[160:163], v[48:51], v[16:19], v[160:163]
    ds_read_b64_tr_b16 v[60:61], v6 offset:0
    v_mfma_f32_16x16x32_bf16 v[228:231], v[20:23], v[32:35], v[228:231]
    ds_read_b64_tr_b16 v[62:63], v6 offset:512
    v_mfma_f32_16x16x32_bf16 v[244:247], v[20:23], v[36:39], v[244:247]
    ds_read_b64_tr_b16 v[64:65], v5 offset:8192
    v_mfma_f32_16x16x32_bf16 v[100:103], v[40:43], v[20:23], v[100:103]
    ds_read_b64_tr_b16 v[66:67], v5 offset:8704
    v_mfma_f32_16x16x32_bf16 v[116:119], v[44:47], v[20:23], v[116:119]
    ds_read_b64_tr_b16 v[68:69], v6 offset:8192
    v_mfma_f32_16x16x32_bf16 v[164:167], v[48:51], v[20:23], v[164:167]
    ds_read_b64_tr_b16 v[70:71], v6 offset:8704
    s_waitcnt lgkmcnt(10)
    s_nop 0
    v_mfma_f32_16x16x32_bf16 v[232:235], v[24:27], v[32:35], v[232:235]
    v_mfma_f32_16x16x32_bf16 v[248:251], v[24:27], v[36:39], v[248:251]
    v_mfma_f32_16x16x32_bf16 v[104:107], v[40:43], v[24:27], v[104:107]
    v_mfma_f32_16x16x32_bf16 v[120:123], v[44:47], v[24:27], v[120:123]
    v_mfma_f32_16x16x32_bf16 v[168:171], v[48:51], v[24:27], v[168:171]
    v_mfma_f32_16x16x32_bf16 v[236:239], v[28:31], v[32:35], v[236:239]
    v_mfma_f32_16x16x32_bf16 v[252:255], v[28:31], v[36:39], v[252:255]
    v_mfma_f32_16x16x32_bf16 v[108:111], v[40:43], v[28:31], v[108:111]
    v_mfma_f32_16x16x32_bf16 v[124:127], v[44:47], v[28:31], v[124:127]
    v_mfma_f32_16x16x32_bf16 v[172:175], v[48:51], v[28:31], v[172:175]
    s_waitcnt lgkmcnt(0)
    s_nop 0
    v_mfma_f32_16x16x32_bf16 v[176:179], v[52:55], v[16:19], v[176:179]
    ds_read_b64_tr_b16 v[32:33], v7 offset:2048
    v_mfma_f32_16x16x32_bf16 v[128:131], v[56:59], v[16:19], v[128:131]
    ds_read_b64_tr_b16 v[34:35], v7 offset:2304
    v_mfma_f32_16x16x32_bf16 v[144:147], v[60:63], v[16:19], v[144:147]
    ds_read_b64_tr_b16 v[36:37], v14 offset:2048
    v_mfma_f32_16x16x32_bf16 v[192:195], v[64:67], v[16:19], v[192:195]
    ds_read_b64_tr_b16 v[38:39], v14 offset:2304
    v_mfma_f32_16x16x32_bf16 v[208:211], v[68:71], v[16:19], v[208:211]
    ds_read_b128 v[16:19], v2 offset:0
    v_mfma_f32_16x16x32_bf16 v[180:183], v[52:55], v[20:23], v[180:183]
    ds_read_b64_tr_b16 v[40:41], v3 offset:4096
    v_mfma_f32_16x16x32_bf16 v[132:135], v[56:59], v[20:23], v[132:135]
    ds_read_b64_tr_b16 v[42:43], v3 offset:4608
    v_mfma_f32_16x16x32_bf16 v[148:151], v[60:63], v[20:23], v[148:151]
    ds_read_b64_tr_b16 v[44:45], v4 offset:4096
    v_mfma_f32_16x16x32_bf16 v[196:199], v[64:67], v[20:23], v[196:199]
    ds_read_b64_tr_b16 v[46:47], v4 offset:4608
    v_mfma_f32_16x16x32_bf16 v[212:215], v[68:71], v[20:23], v[212:215]
    ds_read_b128 v[20:23], v2 offset:2048
    v_mfma_f32_16x16x32_bf16 v[184:187], v[52:55], v[24:27], v[184:187]
    ds_read_b64_tr_b16 v[48:49], v3 offset:12288
    v_mfma_f32_16x16x32_bf16 v[136:139], v[56:59], v[24:27], v[136:139]
    ds_read_b64_tr_b16 v[50:51], v3 offset:12800
    v_mfma_f32_16x16x32_bf16 v[152:155], v[60:63], v[24:27], v[152:155]
    s_add_u32 s59, s59, 1
    s_nop 0
    v_mfma_f32_16x16x32_bf16 v[200:203], v[64:67], v[24:27], v[200:203]
    s_cmp_eq_u32 s59, 3
    s_nop 0
    v_mfma_f32_16x16x32_bf16 v[216:219], v[68:71], v[24:27], v[216:219]
    ds_read_b128 v[24:27], v2 offset:4096
    v_mfma_f32_16x16x32_bf16 v[188:191], v[52:55], v[28:31], v[188:191]
    s_cselect_b32 s59, 0, s59
    s_nop 0
    v_mfma_f32_16x16x32_bf16 v[140:143], v[56:59], v[28:31], v[140:143]
    s_cselect_b32 s56, s71, s70
    s_nop 0
    v_mfma_f32_16x16x32_bf16 v[156:159], v[60:63], v[28:31], v[156:159]
    s_cselect_b32 s57, s73, s72
    s_nop 0
    v_mfma_f32_16x16x32_bf16 v[204:207], v[64:67], v[28:31], v[204:207]
    v_mfma_f32_16x16x32_bf16 v[220:223], v[68:71], v[28:31], v[220:223]
    ds_read_b128 v[28:31], v2 offset:6144
L_KS1:
    s_waitcnt lgkmcnt(2)
    s_nop 0
    v_mfma_f32_16x16x32_bf16 v[224:227], v[16:19], v[32:35], v[224:227]
    ds_read_b64_tr_b16 v[52:53], v4 offset:12288
    v_mfma_f32_16x16x32_bf16 v[240:243], v[16:19], v[36:39], v[240:243]
    ds_read_b64_tr_b16 v[54:55], v4 offset:12800
    v_mfma_f32_16x16x32_bf16 v[96:99], v[40:43], v[16:19], v[96:99]
    ds_read_b64_tr_b16 v[56:57], v5 offset:4096
    v_mfma_f32_16x16x32_bf16 v[112:115], v[44:47], v[16:19], v[112:115]
    ds_read_b64_tr_b16 v[58:59], v5 offset:4608
    v_mfma_f32_16x16x32_bf16 v[160:163], v[48:51], v[16:19], v[160:163]
    ds_read_b64_tr_b16 v[60:61], v6 offset:4096
    v_mfma_f32_16x16x32_bf16 v[228:231], v[20:23], v[32:35], v[228:231]
    ds_read_b64_tr_b16 v[62:63], v6 offset:4608
    v_mfma_f32_16x16x32_bf16 v[244:247], v[20:23], v[36:39], v[244:247]
    ds_read_b64_tr_b16 v[64:65], v5 offset:12288
    v_mfma_f32_16x16x32_bf16 v[100:103], v[40:43], v[20:23], v[100:103]
    ds_read_b64_tr_b16 v[66:67], v5 offset:12800
    v_mfma_f32_16x16x32_bf16 v[116:119], v[44:47], v[20:23], v[116:119]
    ds_read_b64_tr_b16 v[68:69], v6 offset:12288
    v_mfma_f32_16x16x32_bf16 v[164:167], v[48:51], v[20:23], v[164:167]
    ds_read_b64_tr_b16 v[70:71], v6 offset:12800
    s_waitcnt lgkmcnt(10)
    s_nop 0
    v_mfma_f32_16x16x32_bf16 v[232:235], v[24:27], v[32:35], v[232:235]
    v_add_u32_e64 v1, s56, v1
    v_mfma_f32_16x16x32_bf16 v[248:251], v[24:27], v[36:39], v[248:251]
    v_add_u32_e64 v2, s56, v2
    v_mfma_f32_16x16x32_bf16 v[104:107], v[40:43], v[24:27], v[104:107]
    v_add_u32_e64 v3, s57, v3
    v_mfma_f32_16x16x32_bf16 v[120:123], v[44:47], v[24:27], v[120:123]
    v_add_u32_e64 v4, s57, v4
    v_mfma_f32_16x16x32_bf16 v[168:171], v[48:51], v[24:27], v[168:171]
    v_add_u32_e64 v5, s57, v5
    v_mfma_f32_16x16x32_bf16 v[236:239], v[28:31], v[32:35], v[236:239]
    v_add_u32_e64 v6, s57, v6
    v_mfma_f32_16x16x32_bf16 v[252:255], v[28:31], v[36:39], v[252:255]
    v_add_u32_e64 v7, s57, v7
    v_mfma_f32_16x16x32_bf16 v[108:111], v[40:43], v[28:31], v[108:111]
    v_add_u32_e64 v14, s57, v14
    v_mfma_f32_16x16x32_bf16 v[124:127], v[44:47], v[28:31], v[124:127]
    s_sub_u32 s74, s74, 1
    s_nop 0
    v_mfma_f32_16x16x32_bf16 v[172:175], v[48:51], v[28:31], v[172:175]
    s_waitcnt lgkmcnt(0)
    s_nop 0
    v_mfma_f32_16x16x32_bf16 v[176:179], v[52:55], v[16:19], v[176:179]
    s_barrier
    s_nop 0
    ds_read_b64_tr_b16 v[32:33], v7 offset:0
    v_mfma_f32_16x16x32_bf16 v[128:131], v[56:59], v[16:19], v[128:131]
    ds_read_b64_tr_b16 v[34:35], v7 offset:256
    v_mfma_f32_16x16x32_bf16 v[144:147], v[60:63], v[16:19], v[144:147]
    ds_read_b64_tr_b16 v[36:37], v14 offset:0
    v_mfma_f32_16x16x32_bf16 v[192:195], v[64:67], v[16:19], v[192:195]
    ds_read_b64_tr_b16 v[38:39], v14 offset:256
    v_mfma_f32_16x16x32_bf16 v[208:211], v[68:71], v[16:19], v[208:211]
    ds_read_b128 v[16:19], v1 offset:0
    v_mfma_f32_16x16x32_bf16 v[180:183], v[52:55], v[20:23], v[180:183]
    ds_read_b64_tr_b16 v[40:41], v3 offset:0
    v_mfma_f32_16x16x32_bf16 v[132:135], v[56:59], v[20:23], v[132:135]
    ds_read_b64_tr_b16 v[42:43], v3 offset:512
    v_mfma_f32_16x16x32_bf16 v[148:151], v[60:63], v[20:23], v[148:151]
    ds_read_b64_tr_b16 v[44:45], v4 offset:0
    v_mfma_f32_16x16x32_bf16 v[196:199], v[64:67], v[20:23], v[196:199]
    ds_read_b64_tr_b16 v[46:47], v4 offset:512
    v_mfma_f32_16x16x32_bf16 v[212:215], v[68:71], v[20:23], v[212:215]
    ds_read_b128 v[20:23], v1 offset:2048
    v_mfma_f32_16x16x32_bf16 v[184:187], v[52:55], v[24:27], v[184:187]
    ds_read_b64_tr_b16 v[48:49], v3 offset:8192
    v_mfma_f32_16x16x32_bf16 v[136:139], v[56:59], v[24:27], v[136:139]
    ds_read_b64_tr_b16 v[50:51], v3 offset:8704
    v_mfma_f32_16x16x32_bf16 v[152:155], v[60:63], v[24:27], v[152:155]
    v_mfma_f32_16x16x32_bf16 v[200:203], v[64:67], v[24:27], v[200:203]
    v_mfma_f32_16x16x32_bf16 v[216:219], v[68:71], v[24:27], v[216:219]
    ds_read_b128 v[24:27], v1 offset:4096
    v_mfma_f32_16x16x32_bf16 v[188:191], v[52:55], v[28:31], v[188:191]
    v_mfma_f32_16x16x32_bf16 v[140:143], v[56:59], v[28:31], v[140:143]
    v_mfma_f32_16x16x32_bf16 v[156:159], v[60:63], v[28:31], v[156:159]
    v_mfma_f32_16x16x32_bf16 v[204:207], v[64:67], v[28:31], v[204:207]
    v_mfma_f32_16x16x32_bf16 v[220:223], v[68:71], v[28:31], v[220:223]
    ds_read_b128 v[28:31], v1 offset:6144
    s_cmp_lg_u32 s74, 0
    s_cbranch_scc1 L_LOOP
    s_waitcnt lgkmcnt(9)
    s_nop 0
    v_mfma_f32_16x16x32_bf16 v[224:227], v[16:19], v[32:35], v[224:227]
    ds_read_b64_tr_b16 v[92:93], v7 offset:2048
    ds_read_b64_tr_b16 v[94:95], v7 offset:2304
    v_mfma_f32_16x16x32_bf16 v[240:243], v[16:19], v[36:39], v[240:243]
    ds_read_b128 v[52:55], v2 offset:0
    ds_read_b128 v[56:59], v2 offset:2048
    s_waitcnt lgkmcnt(11)
    s_nop 0
    v_mfma_f32_16x16x32_bf16 v[96:99], v[40:43], v[16:19], v[96:99]
    ds_read_b128 v[60:63], v2 offset:4096
    ds_read_b128 v[64:67], v2 offset:6144
    s_waitcnt lgkmcnt(10)
    s_nop 0
    v_mfma_f32_16x16x32_bf16 v[228:231], v[20:23], v[32:35], v[228:231]
    ds_read_b64_tr_b16 v[68:69], v14 offset:2048
    ds_read_b64_tr_b16 v[70:71], v14 offset:2304
    v_mfma_f32_16x16x32_bf16 v[244:247], v[20:23], v[36:39], v[244:247]
    v_mfma_f32_16x16x32_bf16 v[100:103], v[40:43], v[20:23], v[100:103]
    s_waitcnt lgkmcnt(9)
    s_nop 0
    v_mfma_f32_16x16x32_bf16 v[232:235], v[24:27], v[32:35], v[232:235]
    v_mfma_f32_16x16x32_bf16 v[248:251], v[24:27], v[36:39], v[248:251]
    v_mfma_f32_16x16x32_bf16 v[104:107], v[40:43], v[24:27], v[104:107]
    s_waitcnt lgkmcnt(8)
    s_nop 0
    v_mfma_f32_16x16x32_bf16 v[236:239], v[28:31], v[32:35], v[236:239]
    ds_read_b64_tr_b16 v[32:33], v4 offset:8192
    ds_read_b64_tr_b16 v[34:35], v4 offset:8704
    v_mfma_f32_16x16x32_bf16 v[252:255], v[28:31], v[36:39], v[252:255]
    ds_read_b64_tr_b16 v[36:37], v3 offset:4096
    ds_read_b64_tr_b16 v[38:39], v3 offset:4608
    v_mfma_f32_16x16x32_bf16 v[108:111], v[40:43], v[28:31], v[108:111]
    ds_read_b64_tr_b16 v[40:41], v4 offset:4096
    ds_read_b64_tr_b16 v[42:43], v4 offset:4608
    s_waitcnt lgkmcnt(8)
    s_nop 0
    v_mfma_f32_16x16x32_bf16 v[224:227], v[52:55], v[92:95], v[224:227]
    v_mfma_f32_16x16x32_bf16 v[228:231], v[56:59], v[92:95], v[228:231]
    v_mfma_f32_16x16x32_bf16 v[232:235], v[60:63], v[92:95], v[232:235]
    v_mfma_f32_16x16x32_bf16 v[236:239], v[64:67], v[92:95], v[236:239]
    ds_read_b64_tr_b16 v[92:93], v3 offset:12288
    ds_read_b64_tr_b16 v[94:95], v3 offset:12800
    s_waitcnt lgkmcnt(8)
    s_nop 0
    v_mfma_f32_16x16x32_bf16 v[240:243], v[52:55], v[68:71], v[240:243]
    v_mfma_f32_16x16x32_bf16 v[244:247], v[56:59], v[68:71], v[244:247]
    v_mfma_f32_16x16x32_bf16 v[248:251], v[60:63], v[68:71], v[248:251]
    v_mul_f32 v84, s67, v224
    v_mul_f32 v85, s67, v225
    v_exp_f32_e64 v84, v84 clamp
    v_mfma_f32_16x16x32_bf16 v[252:255], v[64:67], v[68:71], v[252:255]
    ds_read_b64_tr_b16 v[68:69], v4 offset:12288
    ds_read_b64_tr_b16 v[70:71], v4 offset:12800
    v_exp_f32_e64 v85, v85 clamp
    v_mfma_f32_16x16x32_bf16 v[112:115], v[44:47], v[16:19], v[112:115]
    v_max_f32 v224, s68, v224
    v_max_f32 v225, s68, v225
    v_add_f32 v84, v84, v224
    v_add_f32 v85, v85, v225
    v_mfma_f32_16x16x32_bf16 v[116:119], v[44:47], v[20:23], v[116:119]
    v_cvt_pk_bf16_f32 v240, v240, v241
    v_cvt_pk_bf16_f32 v224, v84, v85
    v_mul_f32 v86, s67, v226
    v_mul_f32 v87, s67, v227
    v_mfma_f32_16x16x32_bf16 v[120:123], v[44:47], v[24:27], v[120:123]
    v_exp_f32_e64 v86, v86 clamp
    v_exp_f32_e64 v87, v87 clamp
    v_mfma_f32_16x16x32_bf16 v[124:127], v[44:47], v[28:31], v[124:127]
    ds_read_b64_tr_b16 v[44:45], v5 offset:0
    ds_read_b64_tr_b16 v[46:47], v5 offset:512
    v_max_f32 v226, s68, v226
    v_max_f32 v227, s68, v227
    v_mfma_f32_16x16x32_bf16 v[160:163], v[48:51], v[16:19], v[160:163]
    v_add_f32 v86, v86, v226
    v_add_f32 v87, v87, v227
    v_cvt_pk_bf16_f32 v241, v242, v243
    v_cvt_pk_bf16_f32 v225, v86, v87
    v_mfma_f32_16x16x32_bf16 v[164:167], v[48:51], v[20:23], v[164:167]
    v_mul_f32 v84, s67, v228
    v_mul_f32 v85, s67, v229
    v_exp_f32_e64 v84, v84 clamp
    v_mfma_f32_16x16x32_bf16 v[168:171], v[48:51], v[24:27], v[168:171]
    v_exp_f32_e64 v85, v85 clamp
    v_max_f32 v228, s68, v228
    v_max_f32 v229, s68, v229
    v_mfma_f32_16x16x32_bf16 v[172:175], v[48:51], v[28:31], v[172:175]
    ds_read_b64_tr_b16 v[48:49], v6 offset:0
    ds_read_b64_tr_b16 v[50:51], v6 offset:512
    v_add_f32_e64 v84, v84, v228
    v_add_f32 v85, v85, v229
    s_waitcnt lgkmcnt(12)
    v_mfma_f32_16x16x32_bf16 v[176:179], v[32:35], v[16:19], v[176:179]
    v_cvt_pk_bf16_f32 v242, v244, v245
    v_cvt_pk_bf16_f32 v226, v84, v85
    v_mul_f32 v86, s67, v230
    v_mul_f32 v87, s67, v231
    v_mfma_f32_16x16x32_bf16 v[180:183], v[32:35], v[20:23], v[180:183]
    v_exp_f32_e64 v86, v86 clamp
    v_exp_f32_e64 v87, v87 clamp
    v_mfma_f32_16x16x32_bf16 v[184:187], v[32:35], v[24:27], v[184:187]
    v_max_f32 v230, s68, v230
    v_max_f32 v231, s68, v231
    v_add_f32 v86, v86, v230
    v_add_f32 v87, v87, v231
    v_mfma_f32_16x16x32_bf16 v[188:191], v[32:35], v[28:31], v[188:191]
    ds_read_b64_tr_b16 v[32:33], v5 offset:8192
    ds_read_b64_tr_b16 v[34:35], v5 offset:8704
    v_cvt_pk_bf16_f32 v243, v246, v247
    v_cvt_pk_bf16_f32 v227, v86, v87
    s_waitcnt lgkmcnt(12)
    s_nop 0
    v_mfma_f32_16x16x32_bf16 v[96:99], v[36:39], v[52:55], v[96:99]
    v_mul_f32 v84, s67, v232
    v_mul_f32 v85, s67, v233
    v_exp_f32_e64 v84, v84 clamp
    v_mfma_f32_16x16x32_bf16 v[100:103], v[36:39], v[56:59], v[100:103]
    v_exp_f32_e64 v85, v85 clamp
    v_max_f32 v232, s68, v232
    v_max_f32 v233, s68, v233
    v_mfma_f32_16x16x32_bf16 v[104:107], v[36:39], v[60:63], v[104:107]
    v_add_f32 v84, v84, v232
    v_add_f32 v85, v85, v233
    v_cvt_pk_bf16_f32 v244, v248, v249
    v_cvt_pk_bf16_f32 v228, v84, v85
    v_mfma_f32_16x16x32_bf16 v[108:111], v[36:39], v[64:67], v[108:111]
    ds_read_b64_tr_b16 v[36:37], v6 offset:8192
    ds_read_b64_tr_b16 v[38:39], v6 offset:8704
    v_mfma_f32_16x16x32_bf16 v[72:75], v[224:227], v[240:243], 0
    s_waitcnt lgkmcnt(12)
    s_nop 0
    v_mfma_f32_16x16x32_bf16 v[112:115], v[40:43], v[52:55], v[112:115]
    v_mfma_f32_16x16x32_bf16 v[76:79], v[224:227], v[80:83], 0
    v_mfma_f32_16x16x32_bf16 v[116:119], v[40:43], v[56:59], v[116:119]
    v_mul_f32 v86, s67, v234
    v_mul_f32 v87, s67, v235
    v_mfma_f32_16x16x32_bf16 v[120:123], v[40:43], v[60:63], v[120:123]
    v_exp_f32_e64 v86, v86 clamp
    v_exp_f32_e64 v87, v87 clamp
    v_mfma_f32_16x16x32_bf16 v[124:127], v[40:43], v[64:67], v[124:127]
    ds_read_b64_tr_b16 v[40:41], v5 offset:4096
    ds_read_b64_tr_b16 v[42:43], v5 offset:4608
    v_max_f32_e64 v234, s68, v234
    v_max_f32 v235, s68, v235
    s_waitcnt lgkmcnt(12)
    v_mfma_f32_16x16x32_bf16 v[160:163], v[92:95], v[52:55], v[160:163]
    v_add_f32 v86, v86, v234
    v_add_f32 v87, v87, v235
    v_cvt_pk_bf16_f32 v245, v250, v251
    v_cvt_pk_bf16_f32 v229, v86, v87
    v_mfma_f32_16x16x32_bf16 v[164:167], v[92:95], v[56:59], v[164:167]
    v_mul_f32 v84, s67, v236
    v_mul_f32 v85, s67, v237
    v_exp_f32_e64 v84, v84 clamp
    v_mfma_f32_16x16x32_bf16 v[168:171], v[92:95], v[60:63], v[168:171]
    v_exp_f32_e64 v85, v85 clamp
    v_max_f32 v236, s68, v236
    v_max_f32 v237, s68, v237
    v_mfma_f32_16x16x32_bf16 v[172:175], v[92:95], v[64:67], v[172:175]
    ds_read_b64_tr_b16 v[92:93], v6 offset:4096
    ds_read_b64_tr_b16 v[94:95], v6 offset:4608
    v_add_f32_e64 v84, v84, v236
    v_add_f32 v85, v85, v237
    s_waitcnt lgkmcnt(12)
    v_mfma_f32_16x16x32_bf16 v[176:179], v[68:71], v[52:55], v[176:179]
    v_cvt_pk_bf16_f32 v246, v252, v253
    v_cvt_pk_bf16_f32 v230, v84, v85
    v_mul_f32 v86, s67, v238
    v_mul_f32 v87, s67, v239
    v_mfma_f32_16x16x32_bf16 v[180:183], v[68:71], v[56:59], v[180:183]
    v_exp_f32_e64 v86, v86 clamp
    v_exp_f32_e64 v87, v87 clamp
    v_mfma_f32_16x16x32_bf16 v[184:187], v[68:71], v[60:63], v[184:187]
    v_max_f32 v238, s68, v238
    v_max_f32 v239, s68, v239
    v_add_f32 v86, v86, v238
    v_add_f32 v87, v87, v239
    v_mfma_f32_16x16x32_bf16 v[188:191], v[68:71], v[64:67], v[188:191]
    ds_read_b64_tr_b16 v[68:69], v5 offset:12288
    ds_read_b64_tr_b16 v[70:71], v5 offset:12800
    v_cvt_pk_bf16_f32 v247, v254, v255
    v_cvt_pk_bf16_f32 v231, v86, v87
    s_nop 1
    s_nop 0
    v_mfma_f32_16x16x32_bf16 v[72:75], v[228:231], v[244:247], v[72:75]
    v_mfma_f32_16x16x32_bf16 v[76:79], v[228:231], v[80:83], v[76:79]
    s_cmp_ge_u32 s21, 28
    s_cbranch_scc1 L_QEPI
    s_waitcnt lgkmcnt(12)
    s_nop 0
    v_mfma_f32_16x16x32_bf16 v[128:131], v[44:47], v[16:19], v[128:131]
    v_mfma_f32_16x16x32_bf16 v[132:135], v[44:47], v[20:23], v[132:135]
    s_nop 1
    s_nop 0
    ds_write_b128 v9, v[72:75]
    ds_write_b128 v9, v[76:79] offset:1024
    v_mfma_f32_16x16x32_bf16 v[136:139], v[44:47], v[24:27], v[136:139]
    v_mfma_f32_16x16x32_bf16 v[140:143], v[44:47], v[28:31], v[140:143]
    ds_read_b64_tr_b16 v[44:45], v6 offset:12288
    s_waitcnt lgkmcnt(14)
    s_nop 0
    ds_read_b64_tr_b16 v[46:47], v6 offset:12800
    s_waitcnt lgkmcnt(14)
    s_nop 0
    v_mfma_f32_16x16x32_bf16 v[144:147], v[48:51], v[16:19], v[144:147]
    v_mfma_f32_16x16x32_bf16 v[148:151], v[48:51], v[20:23], v[148:151]
    s_waitcnt lgkmcnt(2)
    s_waitcnt vmcnt(0)
    s_barrier
    v_mul_f32 v96, v96, v160
    v_mul_f32 v97, v97, v161
    v_mul_f32 v98, v98, v162
    v_mfma_f32_16x16x32_bf16 v[152:155], v[48:51], v[24:27], v[152:155]
    v_mul_f32 v99, v99, v163
    v_mul_f32 v112, v112, v176
    v_mul_f32_e64 v113, v113, v177
    v_mfma_f32_16x16x32_bf16 v[156:159], v[48:51], v[28:31], v[156:159]
    v_mul_f32 v114, v114, v178
    v_mul_f32 v115, v115, v179
    v_cvt_pk_bf16_f32 v96, v96, v97
    v_mfma_f32_16x16x32_bf16 v[192:195], v[32:35], v[16:19], v[192:195]
    v_cvt_pk_bf16_f32 v97, v98, v99
    v_cvt_pk_bf16_f32 v98, v112, v113
    v_cvt_pk_bf16_f32 v99, v114, v115
    v_mfma_f32_16x16x32_bf16 v[196:199], v[32:35], v[20:23], v[196:199]
    buffer_store_dwordx4 v[96:99], v13, s[40:43], s60 offen offset:0 sc1
    v_mul_f32_e64 v100, v100, v164
    v_mfma_f32_16x16x32_bf16 v[200:203], v[32:35], v[24:27], v[200:203]
    v_mul_f32 v101, v101, v165
    v_mul_f32 v102, v102, v166
    v_mul_f32_e64 v103, v103, v167
    v_mfma_f32_16x16x32_bf16 v[204:207], v[32:35], v[28:31], v[204:207]
    v_mul_f32 v116, v116, v180
    v_mul_f32 v117, v117, v181
    v_mul_f32_e64 v118, v118, v182
    v_mfma_f32_16x16x32_bf16 v[208:211], v[36:39], v[16:19], v[208:211]
    v_mul_f32_e64 v119, v119, v183
    v_cvt_pk_bf16_f32 v100, v100, v101
    v_cvt_pk_bf16_f32 v101, v102, v103
    v_mfma_f32_16x16x32_bf16 v[212:215], v[36:39], v[20:23], v[212:215]
    s_waitcnt lgkmcnt(0)
    s_barrier
    v_cvt_pk_bf16_f32 v102, v116, v117
    v_cvt_pk_bf16_f32 v103, v118, v119
    buffer_store_dwordx4 v[100:103], v13, s[40:43], s60 offen offset:256 sc1
    v_mfma_f32_16x16x32_bf16 v[216:219], v[36:39], v[24:27], v[216:219]
    v_mul_f32 v104, v104, v168
    v_mul_f32 v105, v105, v169
    v_mfma_f32_16x16x32_bf16 v[220:223], v[36:39], v[28:31], v[220:223]
    v_mul_f32 v106, v106, v170
    v_mul_f32 v107, v107, v171
    v_mul_f32_e64 v120, v120, v184
    v_mfma_f32_16x16x32_bf16 v[128:131], v[40:43], v[52:55], v[128:131]
    v_mul_f32 v121, v121, v185
    v_mul_f32 v122, v122, v186
    v_mul_f32_e64 v123, v123, v187
    v_mfma_f32_16x16x32_bf16 v[132:135], v[40:43], v[56:59], v[132:135]
    v_cvt_pk_bf16_f32 v104, v104, v105
    v_cvt_pk_bf16_f32 v105, v106, v107
    v_cvt_pk_bf16_f32 v106, v120, v121
    v_mfma_f32_16x16x32_bf16 v[136:139], v[40:43], v[60:63], v[136:139]
    v_cvt_pk_bf16_f32 v107, v122, v123
    buffer_store_dwordx4 v[104:107], v13, s[40:43], s61 offen offset:0 sc1
    v_mfma_f32_16x16x32_bf16 v[140:143], v[40:43], v[64:67], v[140:143]
    v_mul_f32 v108, v108, v172
    v_mul_f32 v109, v109, v173
    v_mul_f32_e64 v110, v110, v174
    v_mfma_f32_16x16x32_bf16 v[144:147], v[92:95], v[52:55], v[144:147]
    v_mul_f32 v111, v111, v175
    v_mul_f32 v124, v124, v188
    v_mul_f32_e64 v125, v125, v189
    v_mfma_f32_16x16x32_bf16 v[148:151], v[92:95], v[56:59], v[148:151]
    v_mul_f32 v126, v126, v190
    v_mul_f32 v127, v127, v191
    v_cvt_pk_bf16_f32 v108, v108, v109
    v_mfma_f32_16x16x32_bf16 v[152:155], v[92:95], v[60:63], v[152:155]
    v_cvt_pk_bf16_f32 v109, v110, v111
    v_cvt_pk_bf16_f32 v110, v124, v125
    v_cvt_pk_bf16_f32 v111, v126, v127
    v_mfma_f32_16x16x32_bf16 v[156:159], v[92:95], v[64:67], v[156:159]
    buffer_store_dwordx4 v[108:111], v13, s[40:43], s61 offen offset:256 sc1
    v_mfma_f32_16x16x32_bf16 v[192:195], v[68:71], v[52:55], v[192:195]
    v_mfma_f32_16x16x32_bf16 v[196:199], v[68:71], v[56:59], v[196:199]
    v_mfma_f32_16x16x32_bf16 v[200:203], v[68:71], v[60:63], v[200:203]
    v_mfma_f32_16x16x32_bf16 v[204:207], v[68:71], v[64:67], v[204:207]
    v_mfma_f32_16x16x32_bf16 v[208:211], v[44:47], v[52:55], v[208:211]
    v_mfma_f32_16x16x32_bf16 v[212:215], v[44:47], v[56:59], v[212:215]
    v_mfma_f32_16x16x32_bf16 v[216:219], v[44:47], v[60:63], v[216:219]
    v_mfma_f32_16x16x32_bf16 v[220:223], v[44:47], v[64:67], v[220:223]
    s_nop 0
    s_nop 0
    v_pk_mul_f32 v[128:129], v[128:129], v[192:193]
    v_pk_mul_f32 v[130:131], v[130:131], v[194:195]
    s_nop 1
    s_nop 0
    v_pk_mul_f32 v[144:145], v[144:145], v[208:209]
    v_pk_mul_f32 v[146:147], v[146:147], v[210:211]
    v_cvt_pk_bf16_f32 v128, v128, v129
    v_cvt_pk_bf16_f32 v129, v130, v131
    v_cvt_pk_bf16_f32 v130, v144, v145
    v_cvt_pk_bf16_f32 v131, v146, v147
    buffer_store_dwordx4 v[128:131], v13, s[40:43], s60 offen offset:2048 sc1
    v_pk_mul_f32 v[132:133], v[132:133], v[196:197]
    v_pk_mul_f32 v[134:135], v[134:135], v[198:199]
    v_pk_mul_f32 v[148:149], v[148:149], v[212:213]
    v_pk_mul_f32 v[150:151], v[150:151], v[214:215]
    v_cvt_pk_bf16_f32 v132, v132, v133
    v_cvt_pk_bf16_f32 v133, v134, v135
    v_cvt_pk_bf16_f32 v134, v148, v149
    v_cvt_pk_bf16_f32 v135, v150, v151
    buffer_store_dwordx4 v[132:135], v13, s[40:43], s60 offen offset:2304 sc1
    v_pk_mul_f32 v[136:137], v[136:137], v[200:201]
    v_pk_mul_f32 v[138:139], v[138:139], v[202:203]
    v_pk_mul_f32 v[152:153], v[152:153], v[216:217]
    v_pk_mul_f32 v[154:155], v[154:155], v[218:219]
    v_cvt_pk_bf16_f32 v136, v136, v137
    v_cvt_pk_bf16_f32 v137, v138, v139
    v_cvt_pk_bf16_f32 v138, v152, v153
    v_cvt_pk_bf16_f32 v139, v154, v155
    buffer_store_dwordx4 v[136:139], v13, s[40:43], s61 offen offset:2048 sc1
    v_pk_mul_f32 v[140:141], v[140:141], v[204:205]
    v_pk_mul_f32 v[142:143], v[142:143], v[206:207]
    v_pk_mul_f32 v[156:157], v[156:157], v[220:221]
    v_pk_mul_f32 v[158:159], v[158:159], v[222:223]
    v_cvt_pk_bf16_f32 v140, v140, v141
    v_cvt_pk_bf16_f32 v141, v142, v143
    v_cvt_pk_bf16_f32 v142, v156, v157
    v_cvt_pk_bf16_f32 v143, v158, v159
    buffer_store_dwordx4 v[140:143], v13, s[40:43], s61 offen offset:2304 sc1
    v_lshrrev_b32 v4, 3, v0
    v_and_b32 v5, 7, v0
    v_lshlrev_b32_e64 v5, 4, v5
    v_lshl_add_u32 v5, v4, 11, v5
    s_lshl_b32 s52, s78, 7
    v_add_u32 v6, s52, v5
    v_xor_b32 v7, 64, v6
    s_lshl_b32 s81, s22, 14
    s_add_u32 s81, s81, 0x18000
    s_lshl_b32 s58, s22, 17
    s_waitcnt vmcnt(0)
    buffer_store_dword v11, off, s[40:43], s66 sc1
    s_add_u32 m0, s81, 0
    s_lshl4_add_u32 s52, s8, s58
    buffer_load_dwordx4 v6, s[96:99], s52 offen lds
    buffer_load_dwordx4 v7, s[96:99], s52 offen offset:1024 lds
    s_add_u32 m0, s81, 2048
    s_lshl4_add_u32 s52, s9, s58
    s_nop 0
    buffer_load_dwordx4 v6, s[96:99], s52 offen lds
    buffer_load_dwordx4 v7, s[96:99], s52 offen offset:1024 lds
    s_add_u32 m0, s81, 4096
    s_lshl4_add_u32 s52, s10, s58
    s_nop 0
    buffer_load_dwordx4 v6, s[96:99], s52 offen lds
    buffer_load_dwordx4 v7, s[96:99], s52 offen offset:1024 lds
    s_add_u32 m0, s81, 6144
    s_lshl4_add_u32 s52, s11, s58
    s_nop 0
    buffer_load_dwordx4 v6, s[96:99], s52 offen lds
    buffer_load_dwordx4 v7, s[96:99], s52 offen offset:1024 lds
    s_add_u32 m0, s81, 8192
    s_lshl4_add_u32 s52, s12, s58
    s_nop 0
    buffer_load_dwordx4 v6, s[96:99], s52 offen lds
    buffer_load_dwordx4 v7, s[96:99], s52 offen offset:1024 lds
    s_add_u32 m0, s81, 10240
    s_lshl4_add_u32 s52, s13, s58
    s_nop 0
    buffer_load_dwordx4 v6, s[96:99], s52 offen lds
    buffer_load_dwordx4 v7, s[96:99], s52 offen offset:1024 lds
    s_add_u32 m0, s81, 12288
    s_lshl4_add_u32 s52, s14, s58
    s_nop 0
    buffer_load_dwordx4 v6, s[96:99], s52 offen lds
    buffer_load_dwordx4 v7, s[96:99], s52 offen offset:1024 lds
    s_add_u32 m0, s81, 14336
    s_lshl4_add_u32 s52, s15, s58
    s_nop 0
    buffer_load_dwordx4 v6, s[96:99], s52 offen lds
    buffer_load_dwordx4 v7, s[96:99], s52 offen offset:1024 lds
    s_sleep 32
    s_branch L_ATT
L_QEPI:
    s_nop 7
    s_nop 0
    s_waitcnt lgkmcnt(12)
    s_nop 0
    v_mfma_f32_16x16x32_bf16 v[128:131], v[44:47], v[16:19], v[128:131]
    v_mfma_f32_16x16x32_bf16 v[132:135], v[44:47], v[20:23], v[132:135]
    ds_write_b128 v9, v[72:75]
    ds_write_b128 v9, v[76:79] offset:1024
    v_mfma_f32_16x16x32_bf16 v[136:139], v[44:47], v[24:27], v[136:139]
    v_mfma_f32_16x16x32_bf16 v[140:143], v[44:47], v[28:31], v[140:143]
    ds_read_b64_tr_b16 v[44:45], v6 offset:12288
    s_waitcnt lgkmcnt(14)
    s_nop 0
    ds_read_b64_tr_b16 v[46:47], v6 offset:12800
    s_waitcnt lgkmcnt(14)
    s_nop 0
    v_mfma_f32_16x16x32_bf16 v[144:147], v[48:51], v[16:19], v[144:147]
    v_mfma_f32_16x16x32_bf16 v[148:151], v[48:51], v[20:23], v[148:151]
    s_waitcnt lgkmcnt(2)
    s_waitcnt vmcnt(0)
    s_barrier
    v_mul_f32 v232, s67, v96
    v_mul_f32 v233, s67, v97
    v_mul_f32 v234, s67, v98
    v_mfma_f32_16x16x32_bf16 v[152:155], v[48:51], v[24:27], v[152:155]
    v_mul_f32 v235, s67, v99
    v_mul_f32 v236, s67, v112
    v_mul_f32_e64 v237, s67, v113
    v_mfma_f32_16x16x32_bf16 v[156:159], v[48:51], v[28:31], v[156:159]
    v_mul_f32 v238, s67, v114
    v_mul_f32 v239, s67, v115
    v_exp_f32_e64 v232, v232 clamp
    v_mfma_f32_16x16x32_bf16 v[192:195], v[32:35], v[16:19], v[192:195]
    v_max_f32_e64 v96, s68, v96
    v_exp_f32_e64 v233, v233 clamp
    v_mfma_f32_16x16x32_bf16 v[196:199], v[32:35], v[20:23], v[196:199]
    v_max_f32_e64 v97, s68, v97
    v_exp_f32_e64 v234, v234 clamp
    v_mfma_f32_16x16x32_bf16 v[200:203], v[32:35], v[24:27], v[200:203]
    v_max_f32_e64 v98, s68, v98
    v_exp_f32_e64 v235, v235 clamp
    v_mfma_f32_16x16x32_bf16 v[204:207], v[32:35], v[28:31], v[204:207]
    v_max_f32_e64 v99, s68, v99
    v_exp_f32_e64 v236, v236 clamp
    v_mfma_f32_16x16x32_bf16 v[208:211], v[36:39], v[16:19], v[208:211]
    v_max_f32_e64 v112, s68, v112
    v_exp_f32_e64 v237, v237 clamp
    v_mfma_f32_16x16x32_bf16 v[212:215], v[36:39], v[20:23], v[212:215]
    s_waitcnt lgkmcnt(0)
    s_barrier
    v_max_f32_e64 v113, s68, v113
    v_exp_f32_e64 v238, v238 clamp
    v_mfma_f32_16x16x32_bf16 v[216:219], v[36:39], v[24:27], v[216:219]
    v_max_f32_e64 v114, s68, v114
    v_exp_f32_e64 v239, v239 clamp
    v_mfma_f32_16x16x32_bf16 v[220:223], v[36:39], v[28:31], v[220:223]
    v_max_f32 v115, s68, v115
    v_add_f32 v96, v96, v232
    v_mfma_f32_16x16x32_bf16 v[128:131], v[40:43], v[52:55], v[128:131]
    v_add_f32 v97, v97, v233
    v_add_f32 v98, v98, v234
    v_add_f32_e64 v99, v99, v235
    v_mfma_f32_16x16x32_bf16 v[132:135], v[40:43], v[56:59], v[132:135]
    v_add_f32 v112, v112, v236
    v_add_f32 v113, v113, v237
    v_add_f32_e64 v114, v114, v238
    v_mfma_f32_16x16x32_bf16 v[136:139], v[40:43], v[60:63], v[136:139]
    v_add_f32_e64 v115, v115, v239
    v_cvt_pk_bf16_f32 v96, v96, v97
    v_cvt_pk_bf16_f32 v97, v98, v99
    v_mfma_f32_16x16x32_bf16 v[140:143], v[40:43], v[64:67], v[140:143]
    v_cvt_pk_bf16_f32 v98, v112, v113
    v_cvt_pk_bf16_f32 v99, v114, v115
    buffer_store_dwordx4 v[96:99], v13, s[40:43], s62 offen offset:0 sc1
    v_mfma_f32_16x16x32_bf16 v[144:147], v[92:95], v[52:55], v[144:147]
    v_mul_f32 v248, s67, v100
    v_mul_f32 v249, s67, v101
    v_mfma_f32_16x16x32_bf16 v[148:151], v[92:95], v[56:59], v[148:151]
    v_mul_f32 v250, s67, v102
    v_mul_f32 v251, s67, v103
    v_mul_f32_e64 v252, s67, v116
    v_mfma_f32_16x16x32_bf16 v[152:155], v[92:95], v[60:63], v[152:155]
    v_mul_f32 v253, s67, v117
    v_mul_f32 v254, s67, v118
    v_mul_f32_e64 v255, s67, v119
    v_mfma_f32_16x16x32_bf16 v[156:159], v[92:95], v[64:67], v[156:159]
    v_exp_f32_e64 v248, v248 clamp
    v_max_f32_e64 v100, s68, v100
    v_mfma_f32_16x16x32_bf16 v[192:195], v[68:71], v[52:55], v[192:195]
    v_exp_f32_e64 v249, v249 clamp
    v_max_f32_e64 v101, s68, v101
    v_mfma_f32_16x16x32_bf16 v[196:199], v[68:71], v[56:59], v[196:199]
    v_exp_f32_e64 v250, v250 clamp
    v_max_f32_e64 v102, s68, v102
    v_mfma_f32_16x16x32_bf16 v[200:203], v[68:71], v[60:63], v[200:203]
    v_exp_f32_e64 v251, v251 clamp
    v_max_f32_e64 v103, s68, v103
    v_mfma_f32_16x16x32_bf16 v[204:207], v[68:71], v[64:67], v[204:207]
    v_exp_f32_e64 v252, v252 clamp
    v_max_f32_e64 v116, s68, v116
    v_mfma_f32_16x16x32_bf16 v[208:211], v[44:47], v[52:55], v[208:211]
    v_exp_f32_e64 v253, v253 clamp
    v_max_f32_e64 v117, s68, v117
    v_mfma_f32_16x16x32_bf16 v[212:215], v[44:47], v[56:59], v[212:215]
    v_exp_f32_e64 v254, v254 clamp
    v_max_f32_e64 v118, s68, v118
    v_mfma_f32_16x16x32_bf16 v[216:219], v[44:47], v[60:63], v[216:219]
    v_exp_f32_e64 v255, v255 clamp
    v_max_f32_e64 v119, s68, v119
    v_mfma_f32_16x16x32_bf16 v[220:223], v[44:47], v[64:67], v[220:223]
    v_add_f32 v100, v100, v248
    v_add_f32 v101, v101, v249
    v_add_f32 v102, v102, v250
    v_add_f32 v103, v103, v251
    v_add_f32 v116, v116, v252
    v_add_f32 v117, v117, v253
    v_add_f32 v118, v118, v254
    v_add_f32 v119, v119, v255
    v_cvt_pk_bf16_f32 v100, v100, v101
    v_cvt_pk_bf16_f32 v101, v102, v103
    v_cvt_pk_bf16_f32 v102, v116, v117
    v_cvt_pk_bf16_f32 v103, v118, v119
    v_pk_mul_f32 v[232:233], v[104:105], s[66:67] op_sel:[0,1] op_sel_hi:[1,1]
    v_pk_mul_f32 v[234:235], v[106:107], s[66:67] op_sel:[0,1] op_sel_hi:[1,1]
    v_pk_mul_f32 v[236:237], v[120:121], s[66:67] op_sel:[0,1] op_sel_hi:[1,1]
    v_pk_mul_f32 v[238:239], v[122:123], s[66:67] op_sel:[0,1] op_sel_hi:[1,1]
    v_exp_f32_e64 v232, v232 clamp
    v_max_f32_e64 v104, s68, v104
    v_exp_f32_e64 v233, v233 clamp
    v_max_f32_e64 v105, s68, v105
    v_exp_f32_e64 v234, v234 clamp
    v_max_f32_e64 v106, s68, v106
    v_exp_f32_e64 v235, v235 clamp
    v_max_f32_e64 v107, s68, v107
    v_exp_f32_e64 v236, v236 clamp
    v_max_f32_e64 v120, s68, v120
    v_exp_f32_e64 v237, v237 clamp
    v_max_f32_e64 v121, s68, v121
    v_exp_f32_e64 v238, v238 clamp
    v_max_f32_e64 v122, s68, v122
    v_exp_f32_e64 v239, v239 clamp
    v_max_f32_e64 v123, s68, v123
    v_pk_add_f32 v[104:105], v[104:105], v[232:233]
    v_pk_add_f32 v[106:107], v[106:107], v[234:235]
    v_pk_add_f32 v[120:121], v[120:121], v[236:237]
    v_pk_add_f32 v[122:123], v[122:123], v[238:239]
    v_cvt_pk_bf16_f32 v104, v104, v105
    v_cvt_pk_bf16_f32 v105, v106, v107
    v_cvt_pk_bf16_f32 v106, v120, v121
    v_cvt_pk_bf16_f32 v107, v122, v123
    v_pk_mul_f32 v[248:249], v[108:109], s[66:67] op_sel:[0,1] op_sel_hi:[1,1]
    v_pk_mul_f32 v[250:251], v[110:111], s[66:67] op_sel:[0,1] op_sel_hi:[1,1]
    v_pk_mul_f32 v[252:253], v[124:125], s[66:67] op_sel:[0,1] op_sel_hi:[1,1]
    v_pk_mul_f32 v[254:255], v[126:127], s[66:67] op_sel:[0,1] op_sel_hi:[1,1]
    v_exp_f32_e64 v248, v248 clamp
    v_max_f32_e64 v108, s68, v108
    v_exp_f32_e64 v249, v249 clamp
    v_max_f32_e64 v109, s68, v109
    v_exp_f32_e64 v250, v250 clamp
    v_max_f32_e64 v110, s68, v110
    v_exp_f32_e64 v251, v251 clamp
    v_max_f32_e64 v111, s68, v111
    v_exp_f32_e64 v252, v252 clamp
    v_max_f32_e64 v124, s68, v124
    v_exp_f32_e64 v253, v253 clamp
    v_max_f32_e64 v125, s68, v125
    v_exp_f32_e64 v254, v254 clamp
    v_max_f32_e64 v126, s68, v126
    v_exp_f32_e64 v255, v255 clamp
    v_max_f32_e64 v127, s68, v127
    v_pk_add_f32 v[108:109], v[108:109], v[248:249]
    v_pk_add_f32 v[110:111], v[110:111], v[250:251]
    v_pk_add_f32 v[124:125], v[124:125], v[252:253]
    v_pk_add_f32 v[126:127], v[126:127], v[254:255]
    v_cvt_pk_bf16_f32 v108, v108, v109
    v_cvt_pk_bf16_f32 v109, v110, v111
    v_cvt_pk_bf16_f32 v110, v124, v125
    v_cvt_pk_bf16_f32 v111, v126, v127
    v_pk_mul_f32 v[232:233], v[160:161], s[66:67] op_sel:[0,1] op_sel_hi:[1,1]
    v_pk_mul_f32 v[234:235], v[162:163], s[66:67] op_sel:[0,1] op_sel_hi:[1,1]
    v_pk_mul_f32 v[236:237], v[176:177], s[66:67] op_sel:[0,1] op_sel_hi:[1,1]
    v_pk_mul_f32 v[238:239], v[178:179], s[66:67] op_sel:[0,1] op_sel_hi:[1,1]
    v_exp_f32_e64 v232, v232 clamp
    v_max_f32_e64 v160, s68, v160
    v_exp_f32_e64 v233, v233 clamp
    v_max_f32_e64 v161, s68, v161
    v_exp_f32_e64 v234, v234 clamp
    v_max_f32_e64 v162, s68, v162
    v_exp_f32_e64 v235, v235 clamp
    v_max_f32_e64 v163, s68, v163
    v_exp_f32_e64 v236, v236 clamp
    v_max_f32_e64 v176, s68, v176
    v_exp_f32_e64 v237, v237 clamp
    v_max_f32_e64 v177, s68, v177
    v_exp_f32_e64 v238, v238 clamp
    v_max_f32_e64 v178, s68, v178
    v_exp_f32_e64 v239, v239 clamp
    v_max_f32_e64 v179, s68, v179
    v_pk_add_f32 v[160:161], v[160:161], v[232:233]
    v_pk_add_f32 v[162:163], v[162:163], v[234:235]
    v_pk_add_f32 v[176:177], v[176:177], v[236:237]
    v_pk_add_f32 v[178:179], v[178:179], v[238:239]
    v_cvt_pk_bf16_f32 v160, v160, v161
    v_cvt_pk_bf16_f32 v161, v162, v163
    v_cvt_pk_bf16_f32 v162, v176, v177
    v_cvt_pk_bf16_f32 v163, v178, v179
    v_pk_mul_f32 v[248:249], v[164:165], s[66:67] op_sel:[0,1] op_sel_hi:[1,1]
    v_pk_mul_f32 v[250:251], v[166:167], s[66:67] op_sel:[0,1] op_sel_hi:[1,1]
    v_pk_mul_f32 v[252:253], v[180:181], s[66:67] op_sel:[0,1] op_sel_hi:[1,1]
    v_pk_mul_f32 v[254:255], v[182:183], s[66:67] op_sel:[0,1] op_sel_hi:[1,1]
    v_exp_f32_e64 v248, v248 clamp
    v_max_f32_e64 v164, s68, v164
    v_exp_f32_e64 v249, v249 clamp
    v_max_f32_e64 v165, s68, v165
    v_exp_f32_e64 v250, v250 clamp
    v_max_f32_e64 v166, s68, v166
    v_exp_f32_e64 v251, v251 clamp
    v_max_f32_e64 v167, s68, v167
    v_exp_f32_e64 v252, v252 clamp
    v_max_f32_e64 v180, s68, v180
    v_exp_f32_e64 v253, v253 clamp
    v_max_f32_e64 v181, s68, v181
    v_exp_f32_e64 v254, v254 clamp
    v_max_f32_e64 v182, s68, v182
    v_exp_f32_e64 v255, v255 clamp
    v_max_f32_e64 v183, s68, v183
    v_pk_add_f32 v[164:165], v[164:165], v[248:249]
    v_pk_add_f32 v[166:167], v[166:167], v[250:251]
    v_pk_add_f32 v[180:181], v[180:181], v[252:253]
    v_pk_add_f32 v[182:183], v[182:183], v[254:255]
    v_cvt_pk_bf16_f32 v164, v164, v165
    v_cvt_pk_bf16_f32 v165, v166, v167
    v_cvt_pk_bf16_f32 v166, v180, v181
    v_cvt_pk_bf16_f32 v167, v182, v183
    v_pk_mul_f32 v[232:233], v[168:169], s[66:67] op_sel:[0,1] op_sel_hi:[1,1]
    v_pk_mul_f32 v[234:235], v[170:171], s[66:67] op_sel:[0,1] op_sel_hi:[1,1]
    v_pk_mul_f32 v[236:237], v[184:185], s[66:67] op_sel:[0,1] op_sel_hi:[1,1]
    v_pk_mul_f32 v[238:239], v[186:187], s[66:67] op_sel:[0,1] op_sel_hi:[1,1]
    v_exp_f32_e64 v232, v232 clamp
    v_max_f32_e64 v168, s68, v168
    v_exp_f32_e64 v233, v233 clamp
    v_max_f32_e64 v169, s68, v169
    v_exp_f32_e64 v234, v234 clamp
    v_max_f32_e64 v170, s68, v170
    v_exp_f32_e64 v235, v235 clamp
    v_max_f32_e64 v171, s68, v171
    v_exp_f32_e64 v236, v236 clamp
    v_max_f32_e64 v184, s68, v184
    v_exp_f32_e64 v237, v237 clamp
    v_max_f32_e64 v185, s68, v185
    v_exp_f32_e64 v238, v238 clamp
    v_max_f32_e64 v186, s68, v186
    v_exp_f32_e64 v239, v239 clamp
    v_max_f32_e64 v187, s68, v187
    v_pk_add_f32 v[168:169], v[168:169], v[232:233]
    v_pk_add_f32 v[170:171], v[170:171], v[234:235]
    v_pk_add_f32 v[184:185], v[184:185], v[236:237]
    v_pk_add_f32 v[186:187], v[186:187], v[238:239]
    v_cvt_pk_bf16_f32 v168, v168, v169
    v_cvt_pk_bf16_f32 v169, v170, v171
    v_cvt_pk_bf16_f32 v170, v184, v185
    v_cvt_pk_bf16_f32 v171, v186, v187
    v_pk_mul_f32 v[248:249], v[172:173], s[66:67] op_sel:[0,1] op_sel_hi:[1,1]
    v_pk_mul_f32 v[250:251], v[174:175], s[66:67] op_sel:[0,1] op_sel_hi:[1,1]
    v_pk_mul_f32 v[252:253], v[188:189], s[66:67] op_sel:[0,1] op_sel_hi:[1,1]
    v_pk_mul_f32 v[254:255], v[190:191], s[66:67] op_sel:[0,1] op_sel_hi:[1,1]
    v_exp_f32_e64 v248, v248 clamp
    v_max_f32_e64 v172, s68, v172
    v_exp_f32_e64 v249, v249 clamp
    v_max_f32_e64 v173, s68, v173
    v_exp_f32_e64 v250, v250 clamp
    v_max_f32_e64 v174, s68, v174
    v_exp_f32_e64 v251, v251 clamp
    v_max_f32_e64 v175, s68, v175
    v_exp_f32_e64 v252, v252 clamp
    v_max_f32_e64 v188, s68, v188
    v_exp_f32_e64 v253, v253 clamp
    v_max_f32_e64 v189, s68, v189
    v_exp_f32_e64 v254, v254 clamp
    v_max_f32_e64 v190, s68, v190
    v_exp_f32_e64 v255, v255 clamp
    v_max_f32_e64 v191, s68, v191
    v_pk_add_f32 v[172:173], v[172:173], v[248:249]
    v_pk_add_f32 v[174:175], v[174:175], v[250:251]
    v_pk_add_f32 v[188:189], v[188:189], v[252:253]
    v_pk_add_f32 v[190:191], v[190:191], v[254:255]
    v_cvt_pk_bf16_f32 v172, v172, v173
    v_cvt_pk_bf16_f32 v173, v174, v175
    v_cvt_pk_bf16_f32 v174, v188, v189
    v_cvt_pk_bf16_f32 v175, v190, v191
    buffer_store_dwordx4 v[100:103], v13, s[40:43], s62 offen offset:256 sc1
    buffer_store_dwordx4 v[104:107], v13, s[40:43], s64 offen offset:0 sc1
    buffer_store_dwordx4 v[108:111], v13, s[40:43], s64 offen offset:256 sc1
    buffer_store_dwordx4 v[160:163], v13, s[40:43], s63 offen offset:0 sc1
    buffer_store_dwordx4 v[164:167], v13, s[40:43], s63 offen offset:256 sc1
    buffer_store_dwordx4 v[168:171], v13, s[40:43], s65 offen offset:0 sc1
    buffer_store_dwordx4 v[172:175], v13, s[40:43], s65 offen offset:256 sc1
    v_pk_mul_f32 v[232:233], v[128:129], s[66:67] op_sel:[0,1] op_sel_hi:[1,1]
    v_pk_mul_f32 v[234:235], v[130:131], s[66:67] op_sel:[0,1] op_sel_hi:[1,1]
    v_pk_mul_f32 v[236:237], v[144:145], s[66:67] op_sel:[0,1] op_sel_hi:[1,1]
    v_pk_mul_f32 v[238:239], v[146:147], s[66:67] op_sel:[0,1] op_sel_hi:[1,1]
    v_exp_f32_e64 v232, v232 clamp
    v_max_f32_e64 v128, s68, v128
    v_exp_f32_e64 v233, v233 clamp
    v_max_f32_e64 v129, s68, v129
    v_exp_f32_e64 v234, v234 clamp
    v_max_f32_e64 v130, s68, v130
    v_exp_f32_e64 v235, v235 clamp
    v_max_f32_e64 v131, s68, v131
    v_exp_f32_e64 v236, v236 clamp
    v_max_f32_e64 v144, s68, v144
    v_exp_f32_e64 v237, v237 clamp
    v_max_f32_e64 v145, s68, v145
    v_exp_f32_e64 v238, v238 clamp
    v_max_f32_e64 v146, s68, v146
    v_exp_f32_e64 v239, v239 clamp
    v_max_f32_e64 v147, s68, v147
    v_pk_add_f32 v[128:129], v[128:129], v[232:233]
    v_pk_add_f32 v[130:131], v[130:131], v[234:235]
    v_pk_add_f32 v[144:145], v[144:145], v[236:237]
    v_pk_add_f32 v[146:147], v[146:147], v[238:239]
    v_cvt_pk_bf16_f32 v128, v128, v129
    v_cvt_pk_bf16_f32 v129, v130, v131
    v_cvt_pk_bf16_f32 v130, v144, v145
    v_cvt_pk_bf16_f32 v131, v146, v147
    v_pk_mul_f32 v[248:249], v[132:133], s[66:67] op_sel:[0,1] op_sel_hi:[1,1]
    v_pk_mul_f32 v[250:251], v[134:135], s[66:67] op_sel:[0,1] op_sel_hi:[1,1]
    v_pk_mul_f32 v[252:253], v[148:149], s[66:67] op_sel:[0,1] op_sel_hi:[1,1]
    v_pk_mul_f32 v[254:255], v[150:151], s[66:67] op_sel:[0,1] op_sel_hi:[1,1]
    v_exp_f32_e64 v248, v248 clamp
    v_max_f32_e64 v132, s68, v132
    v_exp_f32_e64 v249, v249 clamp
    v_max_f32_e64 v133, s68, v133
    v_exp_f32_e64 v250, v250 clamp
    v_max_f32_e64 v134, s68, v134
    v_exp_f32_e64 v251, v251 clamp
    v_max_f32_e64 v135, s68, v135
    v_exp_f32_e64 v252, v252 clamp
    v_max_f32_e64 v148, s68, v148
    v_exp_f32_e64 v253, v253 clamp
    v_max_f32_e64 v149, s68, v149
    v_exp_f32_e64 v254, v254 clamp
    v_max_f32_e64 v150, s68, v150
    v_exp_f32_e64 v255, v255 clamp
    v_max_f32_e64 v151, s68, v151
    v_pk_add_f32 v[132:133], v[132:133], v[248:249]
    v_pk_add_f32 v[134:135], v[134:135], v[250:251]
    v_pk_add_f32 v[148:149], v[148:149], v[252:253]
    v_pk_add_f32 v[150:151], v[150:151], v[254:255]
    v_cvt_pk_bf16_f32 v132, v132, v133
    v_cvt_pk_bf16_f32 v133, v134, v135
    v_cvt_pk_bf16_f32 v134, v148, v149
    v_cvt_pk_bf16_f32 v135, v150, v151
    v_pk_mul_f32 v[232:233], v[136:137], s[66:67] op_sel:[0,1] op_sel_hi:[1,1]
    v_pk_mul_f32 v[234:235], v[138:139], s[66:67] op_sel:[0,1] op_sel_hi:[1,1]
    v_pk_mul_f32 v[236:237], v[152:153], s[66:67] op_sel:[0,1] op_sel_hi:[1,1]
    v_pk_mul_f32 v[238:239], v[154:155], s[66:67] op_sel:[0,1] op_sel_hi:[1,1]
    v_exp_f32_e64 v232, v232 clamp
    v_max_f32_e64 v136, s68, v136
    v_exp_f32_e64 v233, v233 clamp
    v_max_f32_e64 v137, s68, v137
    v_exp_f32_e64 v234, v234 clamp
    v_max_f32_e64 v138, s68, v138
    v_exp_f32_e64 v235, v235 clamp
    v_max_f32_e64 v139, s68, v139
    v_exp_f32_e64 v236, v236 clamp
    v_max_f32_e64 v152, s68, v152
    v_exp_f32_e64 v237, v237 clamp
    v_max_f32_e64 v153, s68, v153
    v_exp_f32_e64 v238, v238 clamp
    v_max_f32_e64 v154, s68, v154
    v_exp_f32_e64 v239, v239 clamp
    v_max_f32_e64 v155, s68, v155
    v_pk_add_f32 v[136:137], v[136:137], v[232:233]
    v_pk_add_f32 v[138:139], v[138:139], v[234:235]
    v_pk_add_f32 v[152:153], v[152:153], v[236:237]
    v_pk_add_f32 v[154:155], v[154:155], v[238:239]
    v_cvt_pk_bf16_f32 v136, v136, v137
    v_cvt_pk_bf16_f32 v137, v138, v139
    v_cvt_pk_bf16_f32 v138, v152, v153
    v_cvt_pk_bf16_f32 v139, v154, v155
    v_pk_mul_f32 v[248:249], v[140:141], s[66:67] op_sel:[0,1] op_sel_hi:[1,1]
    v_pk_mul_f32 v[250:251], v[142:143], s[66:67] op_sel:[0,1] op_sel_hi:[1,1]
    v_pk_mul_f32 v[252:253], v[156:157], s[66:67] op_sel:[0,1] op_sel_hi:[1,1]
    v_pk_mul_f32 v[254:255], v[158:159], s[66:67] op_sel:[0,1] op_sel_hi:[1,1]
    v_exp_f32_e64 v248, v248 clamp
    v_max_f32_e64 v140, s68, v140
    v_exp_f32_e64 v249, v249 clamp
    v_max_f32_e64 v141, s68, v141
    v_exp_f32_e64 v250, v250 clamp
    v_max_f32_e64 v142, s68, v142
    v_exp_f32_e64 v251, v251 clamp
    v_max_f32_e64 v143, s68, v143
    v_exp_f32_e64 v252, v252 clamp
    v_max_f32_e64 v156, s68, v156
    v_exp_f32_e64 v253, v253 clamp
    v_max_f32_e64 v157, s68, v157
    v_exp_f32_e64 v254, v254 clamp
    v_max_f32_e64 v158, s68, v158
    v_exp_f32_e64 v255, v255 clamp
    v_max_f32_e64 v159, s68, v159
    v_pk_add_f32 v[140:141], v[140:141], v[248:249]
    v_pk_add_f32 v[142:143], v[142:143], v[250:251]
    v_pk_add_f32 v[156:157], v[156:157], v[252:253]
    v_pk_add_f32 v[158:159], v[158:159], v[254:255]
    v_cvt_pk_bf16_f32 v140, v140, v141
    v_cvt_pk_bf16_f32 v141, v142, v143
    v_cvt_pk_bf16_f32 v142, v156, v157
    v_cvt_pk_bf16_f32 v143, v158, v159
    v_pk_mul_f32 v[232:233], v[192:193], s[66:67] op_sel:[0,1] op_sel_hi:[1,1]
    v_pk_mul_f32 v[234:235], v[194:195], s[66:67] op_sel:[0,1] op_sel_hi:[1,1]
    v_pk_mul_f32 v[236:237], v[208:209], s[66:67] op_sel:[0,1] op_sel_hi:[1,1]
    v_pk_mul_f32 v[238:239], v[210:211], s[66:67] op_sel:[0,1] op_sel_hi:[1,1]
    v_exp_f32_e64 v232, v232 clamp
    v_max_f32_e64 v192, s68, v192
    v_exp_f32_e64 v233, v233 clamp
    v_max_f32_e64 v193, s68, v193
    v_exp_f32_e64 v234, v234 clamp
    v_max_f32_e64 v194, s68, v194
    v_exp_f32_e64 v235, v235 clamp
    v_max_f32_e64 v195, s68, v195
    v_exp_f32_e64 v236, v236 clamp
    v_max_f32_e64 v208, s68, v208
    v_exp_f32_e64 v237, v237 clamp
    v_max_f32_e64 v209, s68, v209
    v_exp_f32_e64 v238, v238 clamp
    v_max_f32_e64 v210, s68, v210
    v_exp_f32_e64 v239, v239 clamp
    v_max_f32_e64 v211, s68, v211
    v_pk_add_f32 v[192:193], v[192:193], v[232:233]
    v_pk_add_f32 v[194:195], v[194:195], v[234:235]
    v_pk_add_f32 v[208:209], v[208:209], v[236:237]
    v_pk_add_f32 v[210:211], v[210:211], v[238:239]
    v_cvt_pk_bf16_f32 v192, v192, v193
    v_cvt_pk_bf16_f32 v193, v194, v195
    v_cvt_pk_bf16_f32 v194, v208, v209
    v_cvt_pk_bf16_f32 v195, v210, v211
    v_pk_mul_f32 v[248:249], v[196:197], s[66:67] op_sel:[0,1] op_sel_hi:[1,1]
    v_pk_mul_f32 v[250:251], v[198:199], s[66:67] op_sel:[0,1] op_sel_hi:[1,1]
    v_pk_mul_f32 v[252:253], v[212:213], s[66:67] op_sel:[0,1] op_sel_hi:[1,1]
    v_pk_mul_f32 v[254:255], v[214:215], s[66:67] op_sel:[0,1] op_sel_hi:[1,1]
    v_exp_f32_e64 v248, v248 clamp
    v_max_f32_e64 v196, s68, v196
    v_exp_f32_e64 v249, v249 clamp
    v_max_f32_e64 v197, s68, v197
    v_exp_f32_e64 v250, v250 clamp
    v_max_f32_e64 v198, s68, v198
    v_exp_f32_e64 v251, v251 clamp
    v_max_f32_e64 v199, s68, v199
    v_exp_f32_e64 v252, v252 clamp
    v_max_f32_e64 v212, s68, v212
    v_exp_f32_e64 v253, v253 clamp
    v_max_f32_e64 v213, s68, v213
    v_exp_f32_e64 v254, v254 clamp
    v_max_f32_e64 v214, s68, v214
    v_exp_f32_e64 v255, v255 clamp
    v_max_f32_e64 v215, s68, v215
    v_pk_add_f32 v[196:197], v[196:197], v[248:249]
    v_pk_add_f32 v[198:199], v[198:199], v[250:251]
    v_pk_add_f32 v[212:213], v[212:213], v[252:253]
    v_pk_add_f32 v[214:215], v[214:215], v[254:255]
    v_cvt_pk_bf16_f32 v196, v196, v197
    v_cvt_pk_bf16_f32 v197, v198, v199
    v_cvt_pk_bf16_f32 v198, v212, v213
    v_cvt_pk_bf16_f32 v199, v214, v215
    v_pk_mul_f32 v[232:233], v[200:201], s[66:67] op_sel:[0,1] op_sel_hi:[1,1]
    v_pk_mul_f32 v[234:235], v[202:203], s[66:67] op_sel:[0,1] op_sel_hi:[1,1]
    v_pk_mul_f32 v[236:237], v[216:217], s[66:67] op_sel:[0,1] op_sel_hi:[1,1]
    v_pk_mul_f32 v[238:239], v[218:219], s[66:67] op_sel:[0,1] op_sel_hi:[1,1]
    v_exp_f32_e64 v232, v232 clamp
    v_max_f32_e64 v200, s68, v200
    v_exp_f32_e64 v233, v233 clamp
    v_max_f32_e64 v201, s68, v201
    v_exp_f32_e64 v234, v234 clamp
    v_max_f32_e64 v202, s68, v202
    v_exp_f32_e64 v235, v235 clamp
    v_max_f32_e64 v203, s68, v203
    v_exp_f32_e64 v236, v236 clamp
    v_max_f32_e64 v216, s68, v216
    v_exp_f32_e64 v237, v237 clamp
    v_max_f32_e64 v217, s68, v217
    v_exp_f32_e64 v238, v238 clamp
    v_max_f32_e64 v218, s68, v218
    v_exp_f32_e64 v239, v239 clamp
    v_max_f32_e64 v219, s68, v219
    v_pk_add_f32 v[200:201], v[200:201], v[232:233]
    v_pk_add_f32 v[202:203], v[202:203], v[234:235]
    v_pk_add_f32 v[216:217], v[216:217], v[236:237]
    v_pk_add_f32 v[218:219], v[218:219], v[238:239]
    v_cvt_pk_bf16_f32 v200, v200, v201
    v_cvt_pk_bf16_f32 v201, v202, v203
    v_cvt_pk_bf16_f32 v202, v216, v217
    v_cvt_pk_bf16_f32 v203, v218, v219
    buffer_store_dwordx4 v[128:131], v13, s[40:43], s62 offen offset:2048 sc1
    buffer_store_dwordx4 v[132:135], v13, s[40:43], s62 offen offset:2304 sc1
    buffer_store_dwordx4 v[136:139], v13, s[40:43], s64 offen offset:2048 sc1
    buffer_store_dwordx4 v[140:143], v13, s[40:43], s64 offen offset:2304 sc1
    buffer_store_dwordx4 v[192:195], v13, s[40:43], s63 offen offset:2048 sc1
    buffer_store_dwordx4 v[196:199], v13, s[40:43], s63 offen offset:2304 sc1
    buffer_store_dwordx4 v[200:203], v13, s[40:43], s65 offen offset:2048 sc1
    v_pk_mul_f32 v[248:249], v[204:205], s[66:67] op_sel:[0,1] op_sel_hi:[1,1]
    v_pk_mul_f32 v[250:251], v[206:207], s[66:67] op_sel:[0,1] op_sel_hi:[1,1]
    v_pk_mul_f32 v[252:253], v[220:221], s[66:67] op_sel:[0,1] op_sel_hi:[1,1]
    v_pk_mul_f32 v[254:255], v[222:223], s[66:67] op_sel:[0,1] op_sel_hi:[1,1]
    v_exp_f32_e64 v248, v248 clamp
    v_max_f32_e64 v204, s68, v204
    v_exp_f32_e64 v249, v249 clamp
    v_max_f32_e64 v205, s68, v205
    v_exp_f32_e64 v250, v250 clamp
    v_max_f32_e64 v206, s68, v206
    v_exp_f32_e64 v251, v251 clamp
    v_max_f32_e64 v207, s68, v207
    v_exp_f32_e64 v252, v252 clamp
    v_max_f32_e64 v220, s68, v220
    v_exp_f32_e64 v253, v253 clamp
    v_max_f32_e64 v221, s68, v221
    v_exp_f32_e64 v254, v254 clamp
    v_max_f32_e64 v222, s68, v222
    v_exp_f32_e64 v255, v255 clamp
    v_max_f32_e64 v223, s68, v223
    v_pk_add_f32 v[204:205], v[204:205], v[248:249]
    v_pk_add_f32 v[206:207], v[206:207], v[250:251]
    v_pk_add_f32 v[220:221], v[220:221], v[252:253]
    v_pk_add_f32 v[222:223], v[222:223], v[254:255]
    v_cvt_pk_bf16_f32 v204, v204, v205
    v_cvt_pk_bf16_f32 v205, v206, v207
    v_cvt_pk_bf16_f32 v206, v220, v221
    v_cvt_pk_bf16_f32 v207, v222, v223
    buffer_store_dwordx4 v[204:207], v13, s[40:43], s65 offen offset:2304 sc1
    v_lshrrev_b32 v4, 3, v0
    v_and_b32 v5, 7, v0
    v_lshlrev_b32_e64 v5, 4, v5
    v_lshl_add_u32 v5, v4, 11, v5
    s_lshl_b32 s52, s78, 7
    v_add_u32 v6, s52, v5
    v_xor_b32 v7, 64, v6
    s_lshl_b32 s81, s22, 14
    s_add_u32 s81, s81, 0x18000
    s_lshl_b32 s58, s22, 17
    s_waitcnt vmcnt(0)
    buffer_store_dword v11, off, s[40:43], s66 sc1
    s_add_u32 m0, s81, 0
    s_lshl4_add_u32 s52, s8, s58
    buffer_load_dwordx4 v6, s[96:99], s52 offen lds
    buffer_load_dwordx4 v7, s[96:99], s52 offen offset:1024 lds
    s_add_u32 m0, s81, 2048
    s_lshl4_add_u32 s52, s9, s58
    s_nop 0
    buffer_load_dwordx4 v6, s[96:99], s52 offen lds
    buffer_load_dwordx4 v7, s[96:99], s52 offen offset:1024 lds
    s_add_u32 m0, s81, 4096
    s_lshl4_add_u32 s52, s10, s58
    s_nop 0
    buffer_load_dwordx4 v6, s[96:99], s52 offen lds
    buffer_load_dwordx4 v7, s[96:99], s52 offen offset:1024 lds
    s_add_u32 m0, s81, 6144
    s_lshl4_add_u32 s52, s11, s58
    s_nop 0
    buffer_load_dwordx4 v6, s[96:99], s52 offen lds
    buffer_load_dwordx4 v7, s[96:99], s52 offen offset:1024 lds
    s_add_u32 m0, s81, 8192
    s_lshl4_add_u32 s52, s12, s58
    s_nop 0
    buffer_load_dwordx4 v6, s[96:99], s52 offen lds
    buffer_load_dwordx4 v7, s[96:99], s52 offen offset:1024 lds
    s_add_u32 m0, s81, 10240
    s_lshl4_add_u32 s52, s13, s58
    s_nop 0
    buffer_load_dwordx4 v6, s[96:99], s52 offen lds
    buffer_load_dwordx4 v7, s[96:99], s52 offen offset:1024 lds
    s_add_u32 m0, s81, 12288
    s_lshl4_add_u32 s52, s14, s58
    s_nop 0
    buffer_load_dwordx4 v6, s[96:99], s52 offen lds
    buffer_load_dwordx4 v7, s[96:99], s52 offen offset:1024 lds
    s_add_u32 m0, s81, 14336
    s_lshl4_add_u32 s52, s15, s58
    s_nop 0
    buffer_load_dwordx4 v6, s[96:99], s52 offen lds
    buffer_load_dwordx4 v7, s[96:99], s52 offen offset:1024 lds
L_ATT:
    s_lshl_b32 s52, s77, 16
    s_lshl_b32 s53, s22, 13
    s_add_u32 s52, s52, s53
    s_add_u32 s52, s52, 0x700000
    v_add_u32 v1, s52, v8
    v_add_u32 v2, 0x8000, v1
    v_bfe_u32 v8, v0, 1, 1
    v_bfe_u32 v4, v0, 4, 1
    v_lshl_add_u32 v8, v4, 1, v8
    v_bfe_u32 v4, v0, 2, 1
    v_lshl_add_u32 v8, v4, 2, v8
    v_lshlrev_b32_e64 v8, 4, v8
    v_lshl_add_u32 v8, v4, 10, v8
    v_and_b32_e64 v4, 1, v0
    v_lshl_add_u32 v8, v4, 3, v8
    v_bfe_u32 v4, v0, 3, 1
    v_lshl_add_u32 v8, v4, 7, v8
    v_lshrrev_b32_e64 v4, 5, v0
    v_lshl_add_u32 v8, v4, 8, v8
    v_add_u32 v8, s81, v8
    v_xor_b32 v9, 64, v8
    v_and_b32_e64 v3, 31, v0
    v_lshlrev_b32 v3, 6, v3
    s_lshl_b32 s83, s77, 11
    s_add_u32 s83, s83, 0xb90000
    v_and_b32 v14, 31, v0
    v_lshrrev_b32 v13, 5, v0
    v_min_u32 v5, 16, v14
    v_lshlrev_b32 v5, 4, v5
    v_lshl_add_u32 v5, v13, 9, v5
    s_lshl_b32 s52, s22, 14
    s_add_u32 s52, s52, 0xb00000
    v_add_u32 v5, s52, v5
    v_lshrrev_b32 v12, 3, v0
    v_and_b32 v13, 7, v0
    v_lshlrev_b32_e64 v13, 4, v13
    v_lshl_add_u32 v12, v12, 11, v13
    s_add_u32 s63, s52, 384
    s_add_u32 s52, s22, 28
    s_lshl_b32 s60, 1, s52
    s_and_b32 s53, s77, 3
    s_lshl3_add_u32 s53, s53, s23
    s_lshl_b32 s53, 1, s53
    s_or_b32 s60, s60, s53
    s_mov_b64 s[64:65], -1
    s_movk_i32 s57, 0x7fff
L_APOLL:
    s_mov_b32 exec_lo, s60
    s_mov_b32 exec_hi, 0
    buffer_load_dword v4, v3, s[40:43], s83 offen sc1
    s_mov_b64 exec, s[64:65]
    buffer_load_dwordx4 v[36:39], v12, s[40:43], s63 offen sc1
    s_mov_b64 exec, -1
    s_waitcnt vmcnt(0)
    v_and_b32 v40, v36, v37
    v_and_b32 v41, v38, v39
    v_cmp_eq_u32 vcc, 0, v4
    v_and_b32 v40, v40, v41
    s_and_b32 s52, vcc_lo, s60
    v_cmp_eq_u32 vcc, 0, v40
    s_or_b32 s52, s52, vcc_lo
    s_or_b32 s52, s52, vcc_hi
    s_cbranch_scc0 L_APOLL_OK
    s_or_b64 s[64:65], vcc, 1
    s_sleep 8
    s_sub_u32 s57, s57, 1
    s_cmp_lg_u32 s57, 0
    s_cbranch_scc1 L_APOLL
L_APOLL_OK:
    s_lshl_b32 s52, s8, 1
    s_mov_b32 exec_lo, 0x11ffff
    s_mov_b32 exec_hi, 0x11ffff
    buffer_load_dwordx4 v[128:131], v5, s[40:43], s52 offen sc1
    buffer_load_dwordx4 v[132:135], v5, s[40:43], s52 offen offset:1024 sc1
    s_mov_b64 exec, -1
    buffer_load_dwordx4 v[64:67], v1, s[40:43], s8 offen sc1
    buffer_load_dwordx4 v[68:71], v2, s[40:43], s8 offen sc1
    v_and_b32 v184, 31, v0
    v_lshrrev_b32_e64 v185, 5, v0
    v_mul_u32_u24 v184, 80, v184
    v_lshl_add_u32 v184, v185, 4, v184
    v_add_u32_e64 v188, s81, v184
    v_bfe_u32 v184, v0, 1, 3
    s_lshl_b32 s52, s23, 3
    v_add_u32 v184, s52, v184
    v_mul_u32_u24 v189, 80, v184
    v_lshl_add_u32 v189, v185, 5, v189
    v_and_b32 v186, 1, v0
    s_movk_i32 s52, 5248
    v_mad_u32_u24 v189, v186, s52, v189
    v_bfe_u32 v187, v0, 4, 1
    v_lshl_add_u32 v190, v187, 14, v189
    v_lshl_add_u32 v189, v187, 13, v190
    v_add_u32 v190, 0x18000, v190
    v_and_b32_e64 v191, 48, v0
    v_lshl_add_u32 v191, v186, 6, v191
    v_lshl_add_u32 v191, v184, 10, v191
    v_lshlrev_b32 v185, 2, v185
    v_and_b32 v184, 7, v184
    v_xor_b32_e64 v4, v184, v185
    v_lshlrev_b32 v187, 4, v186
    s_movk_i32 s52, 0x3f80
    v_lshlrev_b32 v187, v187, s52
    v_cmp_eq_u32 vcc, 0, v4
    s_nop 1
    v_cndmask_b32 v184, 0, v187, vcc
    v_cmp_eq_u32 vcc, 1, v4
    s_nop 1
    v_cndmask_b32 v185, 0, v187, vcc
    v_cmp_eq_u32 vcc, 2, v4
    s_nop 1
    v_cndmask_b32 v186, 0, v187, vcc
    v_cmp_eq_u32 vcc, 3, v4
    s_nop 1
    v_cndmask_b32 v187, 0, v187, vcc
    s_waitcnt vmcnt(2)
    v_cvt_pk_bf16_f32 v128, v128, v129
    v_cvt_pk_bf16_f32 v129, v130, v131
    v_cvt_pk_bf16_f32 v130, v132, v133
    v_cvt_pk_bf16_f32 v131, v134, v135
    s_waitcnt vmcnt(1)
    s_waitcnt vmcnt(0)
    v_mfma_f32_32x32x16_bf16 v[32:47], v[128:131], v[64:67], 0
    v_mfma_f32_32x32x16_bf16 v[48:63], v[128:131], v[68:71], 0
    s_lshl_b32 s52, s9, 1
    s_mov_b32 exec_lo, 0x11ffff
    s_mov_b32 exec_hi, 0x11ffff
    buffer_load_dwordx4 v[136:139], v5, s[40:43], s52 offen sc1
    buffer_load_dwordx4 v[140:143], v5, s[40:43], s52 offen offset:1024 sc1
    s_mov_b64 exec, -1
    buffer_load_dwordx4 v[72:75], v1, s[40:43], s9 offen sc1
    buffer_load_dwordx4 v[76:79], v2, s[40:43], s9 offen sc1
    ds_read_b64_tr_b16 v[16:17], v8 offset:0
    ds_read_b64_tr_b16 v[18:19], v8 offset:512
    ds_read_b64_tr_b16 v[20:21], v9 offset:0
    ds_read_b64_tr_b16 v[22:23], v9 offset:512
    v_add_f32 v24, s68, v40
    v_add_f32 v25, s68, v56
    v_rcp_f32 v24, v24
    v_rcp_f32 v25, v25
    v_mul_f32 v32, v32, v24
    v_mul_f32 v33, v33, v24
    v_mul_f32 v34, v34, v24
    v_mul_f32 v35, v35, v24
    v_mul_f32 v36, v36, v24
    v_mul_f32 v37, v37, v24
    v_mul_f32 v38, v38, v24
    v_mul_f32_e64 v39, v39, v24
    v_cvt_pk_bf16_f32 v64, v32, v33
    v_cvt_pk_bf16_f32 v65, v34, v35
    v_cvt_pk_bf16_f32 v66, v36, v37
    v_cvt_pk_bf16_f32 v67, v38, v39
    v_mul_f32 v48, v48, v25
    v_mul_f32 v49, v49, v25
    v_mul_f32 v50, v50, v25
    v_mul_f32 v51, v51, v25
    v_mul_f32 v52, v52, v25
    v_mul_f32 v53, v53, v25
    v_mul_f32 v54, v54, v25
    v_mul_f32 v55, v55, v25
    v_cvt_pk_bf16_f32 v68, v48, v49
    v_cvt_pk_bf16_f32 v69, v50, v51
    v_cvt_pk_bf16_f32 v70, v52, v53
    v_cvt_pk_bf16_f32 v71, v54, v55
    s_waitcnt lgkmcnt(2)
    v_mfma_f32_32x32x16_bf16 v[192:207], v[16:19], v[64:67], 0
    v_mfma_f32_32x32x16_bf16 v[208:223], v[16:19], v[68:71], 0
    s_waitcnt lgkmcnt(0)
    v_mfma_f32_32x32x16_bf16 v[224:239], v[20:23], v[64:67], 0
    v_mfma_f32_32x32x16_bf16 v[240:255], v[20:23], v[68:71], 0
    s_waitcnt vmcnt(2)
    v_cvt_pk_bf16_f32 v136, v136, v137
    v_cvt_pk_bf16_f32 v137, v138, v139
    v_cvt_pk_bf16_f32 v138, v140, v141
    v_cvt_pk_bf16_f32 v139, v142, v143
    s_waitcnt vmcnt(1)
    s_waitcnt vmcnt(0)
    v_mfma_f32_32x32x16_bf16 v[32:47], v[136:139], v[72:75], 0
    v_mfma_f32_32x32x16_bf16 v[48:63], v[136:139], v[76:79], 0
    s_lshl_b32 s52, s10, 1
    s_mov_b32 exec_lo, 0x11ffff
    s_mov_b32 exec_hi, 0x11ffff
    buffer_load_dwordx4 v[144:147], v5, s[40:43], s52 offen sc1
    buffer_load_dwordx4 v[148:151], v5, s[40:43], s52 offen offset:1024 sc1
    s_mov_b64 exec, -1
    buffer_load_dwordx4 v[80:83], v1, s[40:43], s10 offen sc1
    buffer_load_dwordx4 v[84:87], v2, s[40:43], s10 offen sc1
    s_lshl_b32 s52, s11, 1
    s_mov_b32 exec_lo, 0x11ffff
    s_mov_b32 exec_hi, 0x11ffff
    buffer_load_dwordx4 v[152:155], v5, s[40:43], s52 offen sc1
    buffer_load_dwordx4 v[156:159], v5, s[40:43], s52 offen offset:1024 sc1
    s_mov_b64 exec, -1
    buffer_load_dwordx4 v[88:91], v1, s[40:43], s11 offen sc1
    buffer_load_dwordx4 v[92:95], v2, s[40:43], s11 offen sc1
    ds_read_b64_tr_b16 v[16:17], v8 offset:2048
    ds_read_b64_tr_b16 v[18:19], v8 offset:2560
    ds_read_b64_tr_b16 v[20:21], v9 offset:2048
    ds_read_b64_tr_b16 v[22:23], v9 offset:2560
    v_add_f32 v24, s68, v40
    v_add_f32 v25, s68, v56
    v_rcp_f32 v24, v24
    v_rcp_f32 v25, v25
    v_mul_f32 v32, v32, v24
    v_mul_f32 v33, v33, v24
    v_mul_f32 v34, v34, v24
    v_mul_f32 v35, v35, v24
    v_mul_f32 v36, v36, v24
    v_mul_f32 v37, v37, v24
    v_mul_f32 v38, v38, v24
    v_mul_f32_e64 v39, v39, v24
    v_cvt_pk_bf16_f32 v72, v32, v33
    v_cvt_pk_bf16_f32 v73, v34, v35
    v_cvt_pk_bf16_f32 v74, v36, v37
    v_cvt_pk_bf16_f32 v75, v38, v39
    v_mul_f32 v48, v48, v25
    v_mul_f32 v49, v49, v25
    v_mul_f32 v50, v50, v25
    v_mul_f32 v51, v51, v25
    v_mul_f32 v52, v52, v25
    v_mul_f32 v53, v53, v25
    v_mul_f32 v54, v54, v25
    v_mul_f32 v55, v55, v25
    v_cvt_pk_bf16_f32 v76, v48, v49
    v_cvt_pk_bf16_f32 v77, v50, v51
    v_cvt_pk_bf16_f32 v78, v52, v53
    v_cvt_pk_bf16_f32 v79, v54, v55
    s_waitcnt lgkmcnt(2)
    v_mfma_f32_32x32x16_bf16 v[192:207], v[16:19], v[72:75], v[192:207]
    v_mfma_f32_32x32x16_bf16 v[208:223], v[16:19], v[76:79], v[208:223]
    s_waitcnt lgkmcnt(0)
    v_mfma_f32_32x32x16_bf16 v[224:239], v[20:23], v[72:75], v[224:239]
    v_mfma_f32_32x32x16_bf16 v[240:255], v[20:23], v[76:79], v[240:255]
    s_waitcnt vmcnt(6)
    v_cvt_pk_bf16_f32 v144, v144, v145
    v_cvt_pk_bf16_f32 v145, v146, v147
    v_cvt_pk_bf16_f32 v146, v148, v149
    v_cvt_pk_bf16_f32 v147, v150, v151
    s_waitcnt vmcnt(5)
    s_waitcnt vmcnt(4)
    v_mfma_f32_32x32x16_bf16 v[32:47], v[144:147], v[80:83], 0
    v_mfma_f32_32x32x16_bf16 v[48:63], v[144:147], v[84:87], 0
    s_lshl_b32 s52, s12, 1
    s_mov_b32 exec_lo, 0x11ffff
    s_mov_b32 exec_hi, 0x11ffff
    buffer_load_dwordx4 v[160:163], v5, s[40:43], s52 offen sc1
    buffer_load_dwordx4 v[164:167], v5, s[40:43], s52 offen offset:1024 sc1
    s_mov_b64 exec, -1
    buffer_load_dwordx4 v[96:99], v1, s[40:43], s12 offen sc1
    buffer_load_dwordx4 v[100:103], v2, s[40:43], s12 offen sc1
    ds_read_b64_tr_b16 v[16:17], v8 offset:4096
    ds_read_b64_tr_b16 v[18:19], v8 offset:4608
    ds_read_b64_tr_b16 v[20:21], v9 offset:4096
    ds_read_b64_tr_b16 v[22:23], v9 offset:4608
    v_add_f32 v24, s68, v40
    v_add_f32 v25, s68, v56
    v_rcp_f32 v24, v24
    v_rcp_f32 v25, v25
    v_mul_f32 v32, v32, v24
    v_mul_f32 v33, v33, v24
    v_mul_f32 v34, v34, v24
    v_mul_f32 v35, v35, v24
    v_mul_f32 v36, v36, v24
    v_mul_f32 v37, v37, v24
    v_mul_f32 v38, v38, v24
    v_mul_f32_e64 v39, v39, v24
    v_cvt_pk_bf16_f32 v80, v32, v33
    v_cvt_pk_bf16_f32 v81, v34, v35
    v_cvt_pk_bf16_f32 v82, v36, v37
    v_cvt_pk_bf16_f32 v83, v38, v39
    v_mul_f32 v48, v48, v25
    v_mul_f32 v49, v49, v25
    v_mul_f32 v50, v50, v25
    v_mul_f32 v51, v51, v25
    v_mul_f32 v52, v52, v25
    v_mul_f32 v53, v53, v25
    v_mul_f32 v54, v54, v25
    v_mul_f32 v55, v55, v25
    v_cvt_pk_bf16_f32 v84, v48, v49
    v_cvt_pk_bf16_f32 v85, v50, v51
    v_cvt_pk_bf16_f32 v86, v52, v53
    v_cvt_pk_bf16_f32 v87, v54, v55
    s_waitcnt lgkmcnt(2)
    v_mfma_f32_32x32x16_bf16 v[192:207], v[16:19], v[80:83], v[192:207]
    v_mfma_f32_32x32x16_bf16 v[208:223], v[16:19], v[84:87], v[208:223]
    s_waitcnt lgkmcnt(0)
    v_mfma_f32_32x32x16_bf16 v[224:239], v[20:23], v[80:83], v[224:239]
    v_mfma_f32_32x32x16_bf16 v[240:255], v[20:23], v[84:87], v[240:255]
    s_waitcnt vmcnt(6)
    v_cvt_pk_bf16_f32 v152, v152, v153
    v_cvt_pk_bf16_f32 v153, v154, v155
    v_cvt_pk_bf16_f32 v154, v156, v157
    v_cvt_pk_bf16_f32 v155, v158, v159
    s_waitcnt vmcnt(5)
    s_waitcnt vmcnt(4)
    v_mfma_f32_32x32x16_bf16 v[32:47], v[152:155], v[88:91], 0
    v_mfma_f32_32x32x16_bf16 v[48:63], v[152:155], v[92:95], 0
    s_lshl_b32 s52, s13, 1
    s_mov_b32 exec_lo, 0x11ffff
    s_mov_b32 exec_hi, 0x11ffff
    buffer_load_dwordx4 v[168:171], v5, s[40:43], s52 offen sc1
    buffer_load_dwordx4 v[172:175], v5, s[40:43], s52 offen offset:1024 sc1
    s_mov_b64 exec, -1
    buffer_load_dwordx4 v[104:107], v1, s[40:43], s13 offen sc1
    buffer_load_dwordx4 v[108:111], v2, s[40:43], s13 offen sc1
    ds_read_b64_tr_b16 v[16:17], v8 offset:6144
    ds_read_b64_tr_b16 v[18:19], v8 offset:6656
    ds_read_b64_tr_b16 v[20:21], v9 offset:6144
    ds_read_b64_tr_b16 v[22:23], v9 offset:6656
    v_add_f32 v24, s68, v40
    v_add_f32 v25, s68, v56
    v_rcp_f32 v24, v24
    v_rcp_f32 v25, v25
    v_mul_f32 v32, v32, v24
    v_mul_f32 v33, v33, v24
    v_mul_f32 v34, v34, v24
    v_mul_f32 v35, v35, v24
    v_mul_f32 v36, v36, v24
    v_mul_f32 v37, v37, v24
    v_mul_f32 v38, v38, v24
    v_mul_f32_e64 v39, v39, v24
    v_cvt_pk_bf16_f32 v88, v32, v33
    v_cvt_pk_bf16_f32 v89, v34, v35
    v_cvt_pk_bf16_f32 v90, v36, v37
    v_cvt_pk_bf16_f32 v91, v38, v39
    v_mul_f32 v48, v48, v25
    v_mul_f32 v49, v49, v25
    v_mul_f32 v50, v50, v25
    v_mul_f32 v51, v51, v25
    v_mul_f32 v52, v52, v25
    v_mul_f32 v53, v53, v25
    v_mul_f32 v54, v54, v25
    v_mul_f32 v55, v55, v25
    v_cvt_pk_bf16_f32 v92, v48, v49
    v_cvt_pk_bf16_f32 v93, v50, v51
    v_cvt_pk_bf16_f32 v94, v52, v53
    v_cvt_pk_bf16_f32 v95, v54, v55
    s_waitcnt lgkmcnt(2)
    v_mfma_f32_32x32x16_bf16 v[192:207], v[16:19], v[88:91], v[192:207]
    v_mfma_f32_32x32x16_bf16 v[208:223], v[16:19], v[92:95], v[208:223]
    s_waitcnt lgkmcnt(0)
    v_mfma_f32_32x32x16_bf16 v[224:239], v[20:23], v[88:91], v[224:239]
    v_mfma_f32_32x32x16_bf16 v[240:255], v[20:23], v[92:95], v[240:255]
    s_waitcnt vmcnt(6)
    v_cvt_pk_bf16_f32 v160, v160, v161
    v_cvt_pk_bf16_f32 v161, v162, v163
    v_cvt_pk_bf16_f32 v162, v164, v165
    v_cvt_pk_bf16_f32 v163, v166, v167
    s_waitcnt vmcnt(5)
    s_waitcnt vmcnt(4)
    v_mfma_f32_32x32x16_bf16 v[32:47], v[160:163], v[96:99], 0
    v_mfma_f32_32x32x16_bf16 v[48:63], v[160:163], v[100:103], 0
    s_lshl_b32 s52, s14, 1
    s_mov_b32 exec_lo, 0x11ffff
    s_mov_b32 exec_hi, 0x11ffff
    buffer_load_dwordx4 v[176:179], v5, s[40:43], s52 offen sc1
    buffer_load_dwordx4 v[180:183], v5, s[40:43], s52 offen offset:1024 sc1
    s_mov_b64 exec, -1
    buffer_load_dwordx4 v[112:115], v1, s[40:43], s14 offen sc1
    buffer_load_dwordx4 v[116:119], v2, s[40:43], s14 offen sc1
    ds_read_b64_tr_b16 v[16:17], v8 offset:8192
    ds_read_b64_tr_b16 v[18:19], v8 offset:8704
    ds_read_b64_tr_b16 v[20:21], v9 offset:8192
    ds_read_b64_tr_b16 v[22:23], v9 offset:8704
    v_add_f32 v24, s68, v40
    v_add_f32 v25, s68, v56
    v_rcp_f32 v24, v24
    v_rcp_f32 v25, v25
    v_mul_f32 v32, v32, v24
    v_mul_f32 v33, v33, v24
    v_mul_f32 v34, v34, v24
    v_mul_f32 v35, v35, v24
    v_mul_f32 v36, v36, v24
    v_mul_f32 v37, v37, v24
    v_mul_f32 v38, v38, v24
    v_mul_f32_e64 v39, v39, v24
    v_cvt_pk_bf16_f32 v96, v32, v33
    v_cvt_pk_bf16_f32 v97, v34, v35
    v_cvt_pk_bf16_f32 v98, v36, v37
    v_cvt_pk_bf16_f32 v99, v38, v39
    v_mul_f32 v48, v48, v25
    v_mul_f32 v49, v49, v25
    v_mul_f32 v50, v50, v25
    v_mul_f32 v51, v51, v25
    v_mul_f32 v52, v52, v25
    v_mul_f32 v53, v53, v25
    v_mul_f32 v54, v54, v25
    v_mul_f32 v55, v55, v25
    v_cvt_pk_bf16_f32 v100, v48, v49
    v_cvt_pk_bf16_f32 v101, v50, v51
    v_cvt_pk_bf16_f32 v102, v52, v53
    v_cvt_pk_bf16_f32 v103, v54, v55
    s_waitcnt lgkmcnt(2)
    v_mfma_f32_32x32x16_bf16 v[192:207], v[16:19], v[96:99], v[192:207]
    v_mfma_f32_32x32x16_bf16 v[208:223], v[16:19], v[100:103], v[208:223]
    s_waitcnt lgkmcnt(0)
    v_mfma_f32_32x32x16_bf16 v[224:239], v[20:23], v[96:99], v[224:239]
    v_mfma_f32_32x32x16_bf16 v[240:255], v[20:23], v[100:103], v[240:255]
    s_waitcnt vmcnt(6)
    v_cvt_pk_bf16_f32 v168, v168, v169
    v_cvt_pk_bf16_f32 v169, v170, v171
    v_cvt_pk_bf16_f32 v170, v172, v173
    v_cvt_pk_bf16_f32 v171, v174, v175
    s_waitcnt vmcnt(5)
    s_waitcnt vmcnt(4)
    v_mfma_f32_32x32x16_bf16 v[32:47], v[168:171], v[104:107], 0
    v_mfma_f32_32x32x16_bf16 v[48:63], v[168:171], v[108:111], 0
    s_lshl_b32 s52, s15, 1
    s_mov_b32 exec_lo, 0x11ffff
    s_mov_b32 exec_hi, 0x11ffff
    buffer_load_dwordx4 v[128:131], v5, s[40:43], s52 offen sc1
    buffer_load_dwordx4 v[132:135], v5, s[40:43], s52 offen offset:1024 sc1
    s_mov_b64 exec, -1
    buffer_load_dwordx4 v[120:123], v1, s[40:43], s15 offen sc1
    buffer_load_dwordx4 v[124:127], v2, s[40:43], s15 offen sc1
    v_and_b32 v4, 14, v0
    v_lshlrev_b32 v4, 2, v4
    s_lshl_b32 s52, s77, 9
    s_lshl_b32 s53, s23, 6
    s_add_u32 s52, s52, s53
    s_add_u32 s52, s52, 0xb80000
    buffer_load_dwordx2 v[10:11], v4, s[40:43], s52 offen sc1
    ds_read_b64_tr_b16 v[16:17], v8 offset:10240
    ds_read_b64_tr_b16 v[18:19], v8 offset:10752
    ds_read_b64_tr_b16 v[20:21], v9 offset:10240
    ds_read_b64_tr_b16 v[22:23], v9 offset:10752
    v_add_f32 v24, s68, v40
    v_add_f32 v25, s68, v56
    v_rcp_f32 v24, v24
    v_rcp_f32 v25, v25
    v_mul_f32 v32, v32, v24
    v_mul_f32 v33, v33, v24
    v_mul_f32 v34, v34, v24
    v_mul_f32 v35, v35, v24
    v_mul_f32 v36, v36, v24
    v_mul_f32 v37, v37, v24
    v_mul_f32 v38, v38, v24
    v_mul_f32 v39, v39, v24
    v_cvt_pk_bf16_f32 v104, v32, v33
    v_cvt_pk_bf16_f32 v105, v34, v35
    v_cvt_pk_bf16_f32 v106, v36, v37
    v_cvt_pk_bf16_f32 v107, v38, v39
    v_mul_f32 v48, v48, v25
    v_mul_f32 v49, v49, v25
    v_mul_f32 v50, v50, v25
    v_mul_f32 v51, v51, v25
    v_mul_f32 v52, v52, v25
    v_mul_f32 v53, v53, v25
    v_mul_f32 v54, v54, v25
    v_mul_f32 v55, v55, v25
    v_cvt_pk_bf16_f32 v108, v48, v49
    v_cvt_pk_bf16_f32 v109, v50, v51
    v_cvt_pk_bf16_f32 v110, v52, v53
    v_cvt_pk_bf16_f32 v111, v54, v55
    s_waitcnt lgkmcnt(2)
    v_mfma_f32_32x32x16_bf16 v[192:207], v[16:19], v[104:107], v[192:207]
    v_mfma_f32_32x32x16_bf16 v[208:223], v[16:19], v[108:111], v[208:223]
    s_waitcnt lgkmcnt(0)
    v_mfma_f32_32x32x16_bf16 v[224:239], v[20:23], v[104:107], v[224:239]
    v_mfma_f32_32x32x16_bf16 v[240:255], v[20:23], v[108:111], v[240:255]
    s_waitcnt vmcnt(7)
    v_cvt_pk_bf16_f32 v176, v176, v177
    v_cvt_pk_bf16_f32 v177, v178, v179
    v_cvt_pk_bf16_f32 v178, v180, v181
    v_cvt_pk_bf16_f32 v179, v182, v183
    s_waitcnt vmcnt(6)
    s_waitcnt vmcnt(5)
    v_mfma_f32_32x32x16_bf16 v[32:47], v[176:179], v[112:115], 0
    v_mfma_f32_32x32x16_bf16 v[48:63], v[176:179], v[116:119], 0
    ds_read_b64_tr_b16 v[16:17], v8 offset:12288
    ds_read_b64_tr_b16 v[18:19], v8 offset:12800
    ds_read_b64_tr_b16 v[20:21], v9 offset:12288
    ds_read_b64_tr_b16 v[22:23], v9 offset:12800
    s_nop 6
    v_add_f32 v24, s68, v40
    v_add_f32 v25, s68, v56
    v_rcp_f32 v24, v24
    v_rcp_f32 v25, v25
    v_mul_f32 v32, v32, v24
    v_mul_f32 v33, v33, v24
    v_mul_f32 v34, v34, v24
    v_mul_f32 v35, v35, v24
    v_mul_f32 v36, v36, v24
    v_mul_f32 v37, v37, v24
    v_mul_f32 v38, v38, v24
    v_mul_f32 v39, v39, v24
    v_cvt_pk_bf16_f32 v112, v32, v33
    v_cvt_pk_bf16_f32 v113, v34, v35
    v_cvt_pk_bf16_f32 v114, v36, v37
    v_cvt_pk_bf16_f32 v115, v38, v39
    v_mul_f32 v48, v48, v25
    v_mul_f32 v49, v49, v25
    v_mul_f32 v50, v50, v25
    v_mul_f32 v51, v51, v25
    v_mul_f32 v52, v52, v25
    v_mul_f32 v53, v53, v25
    v_mul_f32 v54, v54, v25
    v_mul_f32 v55, v55, v25
    v_cvt_pk_bf16_f32 v116, v48, v49
    v_cvt_pk_bf16_f32 v117, v50, v51
    v_cvt_pk_bf16_f32 v118, v52, v53
    v_cvt_pk_bf16_f32 v119, v54, v55
    s_waitcnt lgkmcnt(2)
    v_mfma_f32_32x32x16_bf16 v[192:207], v[16:19], v[112:115], v[192:207]
    v_mfma_f32_32x32x16_bf16 v[208:223], v[16:19], v[116:119], v[208:223]
    s_waitcnt lgkmcnt(0)
    v_mfma_f32_32x32x16_bf16 v[224:239], v[20:23], v[112:115], v[224:239]
    v_mfma_f32_32x32x16_bf16 v[240:255], v[20:23], v[116:119], v[240:255]
    s_waitcnt vmcnt(3)
    v_cvt_pk_bf16_f32 v128, v128, v129
    v_cvt_pk_bf16_f32 v129, v130, v131
    v_cvt_pk_bf16_f32 v130, v132, v133
    v_cvt_pk_bf16_f32 v131, v134, v135
    s_waitcnt vmcnt(2)
    s_waitcnt vmcnt(1)
    v_mfma_f32_32x32x16_bf16 v[32:47], v[128:131], v[120:123], 0
    v_mfma_f32_32x32x16_bf16 v[48:63], v[128:131], v[124:127], 0
    ds_read_b64_tr_b16 v[16:17], v8 offset:14336
    ds_read_b64_tr_b16 v[18:19], v8 offset:14848
    ds_read_b64_tr_b16 v[20:21], v9 offset:14336
    ds_read_b64_tr_b16 v[22:23], v9 offset:14848
    s_nop 6
    v_add_f32 v24, s68, v40
    v_add_f32 v25, s68, v56
    v_rcp_f32 v24, v24
    v_rcp_f32 v25, v25
    v_mul_f32 v32, v32, v24
    v_mul_f32 v33, v33, v24
    v_mul_f32 v34, v34, v24
    v_mul_f32 v35, v35, v24
    v_mul_f32 v36, v36, v24
    v_mul_f32 v37, v37, v24
    v_mul_f32 v38, v38, v24
    v_mul_f32 v39, v39, v24
    v_cvt_pk_bf16_f32 v120, v32, v33
    v_cvt_pk_bf16_f32 v121, v34, v35
    v_cvt_pk_bf16_f32 v122, v36, v37
    v_cvt_pk_bf16_f32 v123, v38, v39
    v_mul_f32 v48, v48, v25
    v_mul_f32 v49, v49, v25
    v_mul_f32 v50, v50, v25
    v_mul_f32 v51, v51, v25
    v_mul_f32 v52, v52, v25
    v_mul_f32 v53, v53, v25
    v_mul_f32 v54, v54, v25
    v_mul_f32 v55, v55, v25
    v_cvt_pk_bf16_f32 v124, v48, v49
    v_cvt_pk_bf16_f32 v125, v50, v51
    v_cvt_pk_bf16_f32 v126, v52, v53
    v_cvt_pk_bf16_f32 v127, v54, v55
    s_waitcnt lgkmcnt(2)
    v_mfma_f32_32x32x16_bf16 v[192:207], v[16:19], v[120:123], v[192:207]
    v_mfma_f32_32x32x16_bf16 v[208:223], v[16:19], v[124:127], v[208:223]
    s_waitcnt lgkmcnt(0)
    v_mfma_f32_32x32x16_bf16 v[224:239], v[20:23], v[120:123], v[224:239]
    v_mfma_f32_32x32x16_bf16 v[240:255], v[20:23], v[124:127], v[240:255]
    s_nop 7
    v_cvt_pk_bf16_f32 v192, v192, v193
    v_cvt_pk_bf16_f32 v193, v194, v195
    v_cvt_pk_bf16_f32 v194, v196, v197
    v_cvt_pk_bf16_f32 v195, v198, v199
    ds_write_b128 v188, v[192:195] offset:0
    v_cvt_pk_bf16_f32 v200, v200, v201
    v_cvt_pk_bf16_f32 v201, v202, v203
    v_cvt_pk_bf16_f32 v202, v204, v205
    v_cvt_pk_bf16_f32 v203, v206, v207
    ds_write_b128 v188, v[200:203] offset:32
    v_cvt_pk_bf16_f32 v208, v208, v209
    v_cvt_pk_bf16_f32 v209, v210, v211
    v_cvt_pk_bf16_f32 v210, v212, v213
    v_cvt_pk_bf16_f32 v211, v214, v215
    ds_write_b128 v188, v[208:211] offset:2560
    v_cvt_pk_bf16_f32 v216, v216, v217
    v_cvt_pk_bf16_f32 v217, v218, v219
    v_cvt_pk_bf16_f32 v218, v220, v221
    v_cvt_pk_bf16_f32 v219, v222, v223
    ds_write_b128 v188, v[216:219] offset:2592
    v_cvt_pk_bf16_f32 v224, v224, v225
    v_cvt_pk_bf16_f32 v225, v226, v227
    v_cvt_pk_bf16_f32 v226, v228, v229
    v_cvt_pk_bf16_f32 v227, v230, v231
    ds_write_b128 v188, v[224:227] offset:5248
    v_cvt_pk_bf16_f32 v232, v232, v233
    v_cvt_pk_bf16_f32 v233, v234, v235
    v_cvt_pk_bf16_f32 v234, v236, v237
    v_cvt_pk_bf16_f32 v235, v238, v239
    ds_write_b128 v188, v[232:235] offset:5280
    v_cvt_pk_bf16_f32 v240, v240, v241
    v_cvt_pk_bf16_f32 v241, v242, v243
    v_cvt_pk_bf16_f32 v242, v244, v245
    v_cvt_pk_bf16_f32 v243, v246, v247
    ds_write_b128 v188, v[240:243] offset:7808
    v_cvt_pk_bf16_f32 v248, v248, v249
    v_cvt_pk_bf16_f32 v249, v250, v251
    v_cvt_pk_bf16_f32 v250, v252, v253
    v_cvt_pk_bf16_f32 v251, v254, v255
    ds_write_b128 v188, v[248:251] offset:7840
    s_branch L_RED
.section .rodata,"a"
.p2align 6
.amdhsa_kernel gated_mix__linear_attn_block__glu_gated_bilinear__prompt_kernel
  .amdhsa_next_free_vgpr 256
  .amdhsa_next_free_sgpr 102
  .amdhsa_accum_offset 256
  .amdhsa_group_segment_fixed_size 0
  .amdhsa_kernarg_size 88
  .amdhsa_user_sgpr_count 2
  .amdhsa_user_sgpr_kernarg_segment_ptr 1
  .amdhsa_system_sgpr_workgroup_id_x 1
  .amdhsa_float_denorm_mode_32 3
.end_amdhsa_kernel
```
